```python
import torch

def _softmax(x, axis=-1):
    return torch.softmax(x, dim=axis)
def _gelu(x):
    return torch.nn.functional.gelu(x, approximate="tanh")
def _silu(x):
    return torch.nn.functional.silu(x)
def _sigmoid(x):
    return torch.sigmoid(x)
def _layernorm(x, axis=-1, eps=1e-5):
    m = x.mean(dim=axis, keepdim=True)
    v = x.var(dim=axis, keepdim=True, unbiased=False)
    return (x - m) / torch.sqrt(v + eps)
def _scatter_add(tgt, idx, src, axis=0):
    return tgt.clone().index_add_(axis, idx, src)
def _segment_sum(src, seg, n):
    out = torch.zeros((n,) + src.shape[1:], dtype=src.dtype)
    return out.index_add_(0, seg, src)
def _pad(x, pw):
    flat = tuple(v for pair in reversed(pw) for v in pair)
    return torch.nn.functional.pad(x, flat)

kernel_name = 'parallel_sum__gqa_block_cached__dense_activation_silu__decode'

def setup_inputs():

    _w = (lambda a: (lambda t: t.to(torch.bfloat16) if t.is_floating_point() else t)(torch.as_tensor(a)))
    def _A_setup():
        B, Sq, D = 2, 1, 1024
        Hq, Hkv, Sk, Dh = 32, 4, 32768, 128
        assert Hq % Hkv == 0, (Hq, Hkv)
        return {
            "x": _w((lambda *s: torch.randn(*s, dtype=torch.bfloat16) * 0.05)(B, Sq, D)),
            "k_cache": _w((lambda *s: torch.randn(*s, dtype=torch.bfloat16) * 3.2)(B, Hkv, Sk, Dh)),
            "v_cache": _w((lambda *s: torch.randn(*s, dtype=torch.bfloat16) * 0.8)(B, Hkv, Sk, Dh)),
            "wq": _w((lambda *s: torch.randn(*s, dtype=torch.bfloat16) * 3.2)(D, Hq * Dh) * (D ** -0.5)),
            "wo": _w((lambda *s: torch.randn(*s, dtype=torch.bfloat16) * 0.8)(Hq * Dh, D) * ((Hq * Dh) ** -0.5)),
        }
    _A_in = _A_setup()

    def _B_setup():
        B, S, D, F = 2, 1, 1024, 3584
        return {
            "x": _w((lambda *s: torch.randn(*s, dtype=torch.bfloat16) * 0.05)(B, S, D)),
            "w1": _w((lambda *s: torch.randn(*s, dtype=torch.bfloat16) * 3.2)(D, F) * (D ** -0.5)),
            "w2": _w((lambda *s: torch.randn(*s, dtype=torch.bfloat16) * 0.4)(F, D) * (F ** -0.5)),
        }
    _B_in = _B_setup()

    return {
        "A_x": _A_in["x"],
        "A_k_cache": _A_in["k_cache"],
        "A_v_cache": _A_in["v_cache"],
        "A_wq": _A_in["wq"],
        "A_wo": _A_in["wo"],
        "B_x": _B_in["x"],
        "B_w1": _B_in["w1"],
        "B_w2": _B_in["w2"],
    }

def reference(A_x, A_k_cache, A_v_cache, A_wq, A_wo, B_x, B_w1, B_w2):
    def _A_ref(x, k_cache, v_cache, wq, wo):
        B, Sq, D = x.shape
        Hq, Dh = 32, 128
        Hkv = k_cache.shape[1]
        rep = Hq // Hkv
        q = (lambda x, *d: x.permute(*d))((x @ wq).reshape(B, Sq, Hq, Dh), 0, 2, 1, 3)
        k = (lambda x, n, axis: torch.repeat_interleave(x, n, dim=axis))(k_cache, rep, axis=1)
        v = (lambda x, n, axis: torch.repeat_interleave(x, n, dim=axis))(v_cache, rep, axis=1)
        scores = torch.einsum("bhqd,bhkd->bhqk", q, k) * (Dh ** -0.5)
        p = _softmax(scores, axis=-1)
        o = torch.einsum("bhqk,bhkd->bhqd", p, v)
        return (lambda x, *d: x.permute(*d))(o, 0, 2, 1, 3).reshape(B, Sq, Hq * Dh) @ wo

    def _B_ref(x, w1, w2):
        h = torch.einsum("bsd,df->bsf", x, w1)
        h = _silu(h)
        out = torch.einsum("bsf,fd->bsd", h, w2)
        return out

    x = A_x
    xn = _layernorm(x, axis=-1)
    return x + _A_ref(xn, A_k_cache, A_v_cache, A_wq, A_wo) + _B_ref(xn, B_w1, B_w2)
```

```asm
; @launch grid=(256,1,1) block=(512,1,1) lds=45056
.amdgcn_target "amdgcn-amd-amdhsa--gfx950"
.text
.globl parallel_sum__gqa_block_cached__dense_activation_silu__decode_kernel
.p2align 8
.type parallel_sum__gqa_block_cached__dense_activation_silu__decode_kernel,@function
parallel_sum__gqa_block_cached__dense_activation_silu__decode_kernel:
s_cmp_ge_u32 s2, 256
s_cbranch_scc1 L_end
s_load_dwordx2 s[48:49], s[0:1], 24
s_load_dwordx2 s[60:61], s[0:1], 0
s_load_dwordx4 s[16:19], s[0:1], 8
s_load_dwordx2 s[28:29], s[0:1], 48
s_setprio 3
v_lshrrev_b32 v10, 6, v0
v_and_b32 v1, 63, v0
v_readfirstlane_b32 s3, v10
v_lshrrev_b32 v10, 3, v1
v_and_b32 v11, 7, v1
v_lshlrev_b32 v11, 4, v11
v_lshl_add_u32 v4, v10, 15, v11
s_and_b32 s7, s2, 3
s_lshl_b32 s72, s7, 8
s_lshl_b32 s73, s3, 5
s_add_u32 s72, s72, s73
s_lshr_b32 s73, s2, 2
s_lshl_b32 s69, s72, 13
s_lshl_b32 s74, s73, 7
s_add_u32 s69, s69, s74
s_mov_b32 s50, 8388608
s_mov_b32 s51, 0x00020000
s_movk_i32 s62, 4096
s_mov_b32 s63, s51
v_lshlrev_b32 v13, 5, v1
s_waitcnt lgkmcnt(0)
buffer_load_dwordx4 v[64:67], v13, s[60:63], 0 offen offset:0
buffer_load_dwordx4 v[68:71], v13, s[60:63], 0 offen offset:16
buffer_load_dwordx4 v[72:75], v13, s[60:63], 0 offen offset:2048
buffer_load_dwordx4 v[76:79], v13, s[60:63], 0 offen offset:2064
buffer_load_dwordx4 v[224:227], v4, s[48:51], s69 offen nt
s_add_u32 s69, s69, 8192
buffer_load_dwordx4 v[228:231], v4, s[48:51], s69 offen nt
s_add_u32 s69, s69, 8192
buffer_load_dwordx4 v[232:235], v4, s[48:51], s69 offen nt
s_add_u32 s69, s69, 8192
buffer_load_dwordx4 v[236:239], v4, s[48:51], s69 offen nt
v_lshlrev_b32 v14, 2, v1
v_mov_b32 v15, 0
ds_write_b32 v14, v15 offset:11008
s_waitcnt lgkmcnt(0)
s_barrier
s_lshr_b32 s4, s2, 3
s_xor_b32 s4, s4, s2
s_and_b32 s4, s4, 1
s_load_dwordx2 s[56:57], s[0:1], 80
s_mul_i32 s76, s4, 24
s_add_u32 s76, s76, 32
s_load_dwordx2 s[52:53], s[0:1], s76
s_load_dwordx2 s[64:65], s[0:1], 64
v_lshlrev_b32 v12, 3, v10
s_lshl_b32 s74, s72, 1
v_add_u32 v12, s74, v12
buffer_load_dwordx2 v[80:81], v12, s[60:63], 0 offen offset:0
buffer_load_dwordx2 v[82:83], v12, s[60:63], 0 offen offset:2048
v_mul_u32_u24 v5, 28672, v10
v_add_u32 v5, v5, v11
s_lshl_b32 s7, s7, 1
s_add_u32 s7, s7, 1
s_and_b32 s74, s73, 7
s_cmp_lg_u32 s74, s7
s_cselect_b32 s86, 1, 0
s_lshr_b32 s75, s73, 3
s_mul_i32 s75, s75, 7
s_add_u32 s75, s75, s74
s_cmp_gt_u32 s74, s7
s_subb_u32 s39, s75, 0
s_mul_i32 s70, s72, 7168
s_lshl_b32 s74, s39, 7
s_add_u32 s70, s70, s74
s_mul_i32 s30, s86, 7340032
s_mov_b32 s31, 0x00020000
buffer_load_dwordx4 v[240:243], v5, s[28:31], s70 offen nt
s_add_u32 s70, s70, 7168
buffer_load_dwordx4 v[244:247], v5, s[28:31], s70 offen nt
s_add_u32 s70, s70, 7168
buffer_load_dwordx4 v[248:251], v5, s[28:31], s70 offen nt
s_add_u32 s70, s70, 7168
buffer_load_dwordx4 v[252:255], v5, s[28:31], s70 offen nt
s_mov_b32 s40, s16
s_mov_b32 s41, s17
s_mov_b32 s42, 67108864
s_mov_b32 s43, 0x00020000
s_mov_b32 s44, s18
s_mov_b32 s45, s19
s_mov_b32 s46, 67108864
s_mov_b32 s47, 0x00020000
v_lshlrev_b32 v3, 4, v1
v_bfe_u32 v10, v1, 1, 1
v_bfe_u32 v11, v1, 2, 2
v_lshl_add_u32 v10, v10, 2, v11
v_lshlrev_b32 v2, 8, v10
v_lshrrev_b32 v11, 4, v1
v_lshl_add_u32 v2, v11, 5, v2
v_and_b32 v11, 1, v1
v_lshl_add_u32 v2, v11, 4, v2
s_lshl_b32 s68, s2, 18
s_lshl_b32 s7, s3, 12
s_add_u32 s68, s68, s7
s_mov_b32 s58, 4194304
s_mov_b32 s59, 0x00020000
s_mov_b32 s66, 4096
s_mov_b32 s67, 0x00020000
s_waitcnt lgkmcnt(0)
s_load_dword s6, s[56:57], 0
buffer_load_dwordx4 v[96:99], v2, s[40:43], s68 offen offset:0 nt
buffer_load_dwordx4 v[100:103], v2, s[40:43], s68 offen offset:128 nt
buffer_load_dwordx4 v[104:107], v2, s[40:43], s68 offen offset:2048 nt
buffer_load_dwordx4 v[108:111], v2, s[40:43], s68 offen offset:2176 nt
s_mov_b32 s84, 0xffff0000
s_lshr_b32 s5, s2, 1
s_and_b32 s7, s5, 7
s_sub_u32 s54, 8, s4
s_lshl_b32 s54, s54, 20
s_mov_b32 s55, 0x00020000
s_cmp_lg_u32 s7, 7
s_cselect_b32 s85, s4, 0
s_lshr_b32 s7, s5, 3
s_mul_i32 s7, s7, s4
s_sub_u32 s87, s5, s7
s_cmp_eq_u32 s4, s85
s_cselect_b32 s54, s54, 0
s_mov_b32 s8, 0x05040100
s_mov_b32 s9, 0x07060302
s_mov_b32 s10, 0x07060500
s_mov_b32 s11, 0x07060501
s_mov_b32 s12, 0x07060502
s_mov_b32 s13, 0x07060503
s_mov_b32 s14, 0x0c0c0400
s_mov_b32 s23, 0xffffff00
s_mov_b32 s82, 0x3fb8aa3b
s_mov_b32 s83, 0x3db504f3
s_mov_b32 s88, 0x00ff00ff
s_mov_b32 s89, 0x00ff00ff
s_lshl_b32 s71, s87, 16
s_lshl_b32 s7, s3, 8
s_add_u32 s71, s71, s7
s_waitcnt vmcnt(14)
v_lshlrev_b32 v192, 16, v64
v_and_b32 v193, s84, v64
v_lshlrev_b32 v194, 16, v65
v_and_b32 v195, s84, v65
v_lshlrev_b32 v196, 16, v66
v_and_b32 v197, s84, v66
v_lshlrev_b32 v198, 16, v67
v_and_b32 v199, s84, v67
v_lshlrev_b32 v200, 16, v68
v_and_b32 v201, s84, v68
v_lshlrev_b32 v202, 16, v69
v_and_b32 v203, s84, v69
v_lshlrev_b32 v204, 16, v70
v_and_b32 v205, s84, v70
v_lshlrev_b32 v206, 16, v71
v_and_b32 v207, s84, v71
v_lshlrev_b32 v208, 16, v72
v_and_b32 v209, s84, v72
v_lshlrev_b32 v210, 16, v73
v_and_b32 v211, s84, v73
v_lshlrev_b32 v212, 16, v74
v_and_b32 v213, s84, v74
v_lshlrev_b32 v214, 16, v75
v_and_b32 v215, s84, v75
v_lshlrev_b32 v216, 16, v76
v_and_b32 v217, s84, v76
v_lshlrev_b32 v218, 16, v77
v_and_b32 v219, s84, v77
v_lshlrev_b32 v220, 16, v78
v_and_b32 v221, s84, v78
v_lshlrev_b32 v222, 16, v79
v_and_b32 v223, s84, v79
v_pk_add_f32 v[64:65], v[192:193], v[194:195]
v_pk_add_f32 v[66:67], v[196:197], v[198:199]
v_pk_add_f32 v[68:69], v[208:209], v[210:211]
v_pk_add_f32 v[70:71], v[212:213], v[214:215]
v_pk_add_f32 v[64:65], v[64:65], v[200:201]
v_pk_add_f32 v[68:69], v[68:69], v[216:217]
v_pk_add_f32 v[66:67], v[66:67], v[202:203]
v_pk_add_f32 v[70:71], v[70:71], v[218:219]
v_pk_add_f32 v[64:65], v[64:65], v[204:205]
v_pk_add_f32 v[68:69], v[68:69], v[220:221]
v_pk_add_f32 v[66:67], v[66:67], v[206:207]
v_pk_add_f32 v[70:71], v[70:71], v[222:223]
v_pk_add_f32 v[64:65], v[64:65], v[66:67]
v_pk_add_f32 v[68:69], v[68:69], v[70:71]
v_add_f32 v10, v64, v65
v_add_f32 v11, v68, v69
s_nop 0
v_add_f32_dpp v10, v10, v10 row_ror:8 row_mask:0xf bank_mask:0xf
v_add_f32_dpp v11, v11, v11 row_ror:8 row_mask:0xf bank_mask:0xf
s_nop 0
v_add_f32_dpp v10, v10, v10 row_ror:4 row_mask:0xf bank_mask:0xf
v_add_f32_dpp v11, v11, v11 row_ror:4 row_mask:0xf bank_mask:0xf
s_nop 0
v_add_f32_dpp v10, v10, v10 row_ror:2 row_mask:0xf bank_mask:0xf
v_add_f32_dpp v11, v11, v11 row_ror:2 row_mask:0xf bank_mask:0xf
s_nop 0
v_add_f32_dpp v10, v10, v10 row_ror:1 row_mask:0xf bank_mask:0xf
v_add_f32_dpp v11, v11, v11 row_ror:1 row_mask:0xf bank_mask:0xf
v_mov_b32 v12, v10
v_mov_b32 v13, v11
s_nop 0
v_permlane16_swap_b32 v10, v12
v_permlane16_swap_b32 v11, v13
v_add_f32 v10, v10, v12
v_add_f32 v11, v11, v13
v_mov_b32 v12, v10
v_mov_b32 v13, v11
s_nop 0
v_permlane32_swap_b32 v10, v12
v_permlane32_swap_b32 v11, v13
v_add_f32 v10, v10, v12
v_add_f32 v11, v11, v13
v_mul_f32 v10, 0x3a800000, v10
v_mul_f32 v11, 0x3a800000, v11
s_add_u32 s74, s68, 32768
s_waitcnt vmcnt(4)
buffer_load_dwordx4 v[112:115], v2, s[40:43], s74 offen offset:0 nt
s_waitcnt vmcnt(4)
buffer_load_dwordx4 v[116:119], v2, s[40:43], s74 offen offset:128 nt
v_pk_add_f32 v[192:193], v[192:193], v[10:11] op_sel:[0,0] op_sel_hi:[1,0] neg_lo:[0,1] neg_hi:[0,1]
v_pk_add_f32 v[208:209], v[208:209], v[10:11] op_sel:[0,1] op_sel_hi:[1,1] neg_lo:[0,1] neg_hi:[0,1]
v_pk_add_f32 v[194:195], v[194:195], v[10:11] op_sel:[0,0] op_sel_hi:[1,0] neg_lo:[0,1] neg_hi:[0,1]
v_pk_add_f32 v[210:211], v[210:211], v[10:11] op_sel:[0,1] op_sel_hi:[1,1] neg_lo:[0,1] neg_hi:[0,1]
v_pk_add_f32 v[196:197], v[196:197], v[10:11] op_sel:[0,0] op_sel_hi:[1,0] neg_lo:[0,1] neg_hi:[0,1]
v_pk_add_f32 v[212:213], v[212:213], v[10:11] op_sel:[0,1] op_sel_hi:[1,1] neg_lo:[0,1] neg_hi:[0,1]
v_pk_add_f32 v[198:199], v[198:199], v[10:11] op_sel:[0,0] op_sel_hi:[1,0] neg_lo:[0,1] neg_hi:[0,1]
v_pk_add_f32 v[214:215], v[214:215], v[10:11] op_sel:[0,1] op_sel_hi:[1,1] neg_lo:[0,1] neg_hi:[0,1]
v_pk_add_f32 v[200:201], v[200:201], v[10:11] op_sel:[0,0] op_sel_hi:[1,0] neg_lo:[0,1] neg_hi:[0,1]
v_pk_add_f32 v[216:217], v[216:217], v[10:11] op_sel:[0,1] op_sel_hi:[1,1] neg_lo:[0,1] neg_hi:[0,1]
v_pk_add_f32 v[202:203], v[202:203], v[10:11] op_sel:[0,0] op_sel_hi:[1,0] neg_lo:[0,1] neg_hi:[0,1]
v_pk_add_f32 v[218:219], v[218:219], v[10:11] op_sel:[0,1] op_sel_hi:[1,1] neg_lo:[0,1] neg_hi:[0,1]
v_pk_add_f32 v[204:205], v[204:205], v[10:11] op_sel:[0,0] op_sel_hi:[1,0] neg_lo:[0,1] neg_hi:[0,1]
v_pk_add_f32 v[220:221], v[220:221], v[10:11] op_sel:[0,1] op_sel_hi:[1,1] neg_lo:[0,1] neg_hi:[0,1]
v_pk_add_f32 v[206:207], v[206:207], v[10:11] op_sel:[0,0] op_sel_hi:[1,0] neg_lo:[0,1] neg_hi:[0,1]
v_pk_add_f32 v[222:223], v[222:223], v[10:11] op_sel:[0,1] op_sel_hi:[1,1] neg_lo:[0,1] neg_hi:[0,1]
v_pk_mul_f32 v[64:65], v[192:193], v[192:193]
v_pk_mul_f32 v[68:69], v[208:209], v[208:209]
v_pk_fma_f32 v[64:65], v[194:195], v[194:195], v[64:65]
v_pk_fma_f32 v[68:69], v[210:211], v[210:211], v[68:69]
v_pk_fma_f32 v[64:65], v[196:197], v[196:197], v[64:65]
v_pk_fma_f32 v[68:69], v[212:213], v[212:213], v[68:69]
v_pk_fma_f32 v[64:65], v[198:199], v[198:199], v[64:65]
v_pk_fma_f32 v[68:69], v[214:215], v[214:215], v[68:69]
v_pk_fma_f32 v[64:65], v[200:201], v[200:201], v[64:65]
v_pk_fma_f32 v[68:69], v[216:217], v[216:217], v[68:69]
v_pk_fma_f32 v[64:65], v[202:203], v[202:203], v[64:65]
v_pk_fma_f32 v[68:69], v[218:219], v[218:219], v[68:69]
v_pk_fma_f32 v[64:65], v[204:205], v[204:205], v[64:65]
v_pk_fma_f32 v[68:69], v[220:221], v[220:221], v[68:69]
v_pk_fma_f32 v[64:65], v[206:207], v[206:207], v[64:65]
v_pk_fma_f32 v[68:69], v[222:223], v[222:223], v[68:69]
v_add_f32 v14, v64, v65
v_add_f32 v15, v68, v69
s_nop 0
v_add_f32_dpp v14, v14, v14 row_ror:8 row_mask:0xf bank_mask:0xf
v_add_f32_dpp v15, v15, v15 row_ror:8 row_mask:0xf bank_mask:0xf
s_nop 0
v_add_f32_dpp v14, v14, v14 row_ror:4 row_mask:0xf bank_mask:0xf
v_add_f32_dpp v15, v15, v15 row_ror:4 row_mask:0xf bank_mask:0xf
s_nop 0
v_add_f32_dpp v14, v14, v14 row_ror:2 row_mask:0xf bank_mask:0xf
v_add_f32_dpp v15, v15, v15 row_ror:2 row_mask:0xf bank_mask:0xf
s_nop 0
v_add_f32_dpp v14, v14, v14 row_ror:1 row_mask:0xf bank_mask:0xf
v_add_f32_dpp v15, v15, v15 row_ror:1 row_mask:0xf bank_mask:0xf
v_mov_b32 v12, v14
v_mov_b32 v13, v15
s_nop 0
v_permlane16_swap_b32 v14, v12
v_permlane16_swap_b32 v15, v13
v_add_f32 v14, v14, v12
v_add_f32 v15, v15, v13
v_mov_b32 v12, v14
v_mov_b32 v13, v15
s_nop 0
v_permlane32_swap_b32 v14, v12
v_permlane32_swap_b32 v15, v13
v_add_f32 v14, v14, v12
v_add_f32 v15, v15, v13
s_waitcnt vmcnt(4)
buffer_load_dwordx4 v[120:123], v2, s[40:43], s74 offen offset:2048 nt
s_waitcnt vmcnt(4)
buffer_load_dwordx4 v[124:127], v2, s[40:43], s74 offen offset:2176 nt
v_mul_f32 v14, 0x3a800000, v14
v_mul_f32 v15, 0x3a800000, v15
v_cvt_pk_bf16_f32 v12, v10, v11
v_lshlrev_b32 v10, 16, v12
v_and_b32 v11, s84, v12
v_cvt_pk_bf16_f32 v13, v14, v15
v_lshlrev_b32 v14, 16, v13
v_and_b32 v15, s84, v13
v_add_f32 v14, 0x3727c5ac, v14
v_add_f32 v15, 0x3727c5ac, v15
v_cvt_pk_bf16_f32 v13, v14, v15
v_lshlrev_b32 v14, 16, v13
v_and_b32 v15, s84, v13
v_sqrt_f32 v14, v14
v_sqrt_f32 v15, v15
s_nop 0
v_cvt_pk_bf16_f32 v13, v14, v15
v_lshlrev_b32 v14, 16, v13
v_and_b32 v15, s84, v13
v_rcp_f32 v14, v14
v_rcp_f32 v15, v15
s_waitcnt vmcnt(12)
v_lshlrev_b32 v32, 16, v80
v_and_b32 v33, s84, v80
v_lshlrev_b32 v34, 16, v81
v_and_b32 v35, s84, v81
v_lshlrev_b32 v36, 16, v82
v_and_b32 v37, s84, v82
v_lshlrev_b32 v38, 16, v83
v_and_b32 v39, s84, v83
v_sub_f32 v32, v32, v10
v_sub_f32 v33, v33, v10
v_sub_f32 v34, v34, v10
v_sub_f32 v35, v35, v10
v_sub_f32 v36, v36, v11
v_sub_f32 v37, v37, v11
v_sub_f32 v38, v38, v11
v_sub_f32 v39, v39, v11
v_cvt_pk_bf16_f32 v192, v32, v33
v_lshlrev_b32 v32, 16, v192
v_and_b32 v33, s84, v192
v_cvt_pk_bf16_f32 v193, v34, v35
v_lshlrev_b32 v34, 16, v193
v_and_b32 v35, s84, v193
v_cvt_pk_bf16_f32 v194, v36, v37
v_lshlrev_b32 v36, 16, v194
v_and_b32 v37, s84, v194
v_cvt_pk_bf16_f32 v195, v38, v39
v_lshlrev_b32 v38, 16, v195
v_and_b32 v39, s84, v195
v_mul_f32 v32, v32, v14
v_mul_f32 v33, v33, v14
v_mul_f32 v34, v34, v14
v_mul_f32 v35, v35, v14
v_mul_f32 v36, v36, v15
v_mul_f32 v37, v37, v15
v_mul_f32 v38, v38, v15
v_mul_f32 v39, v39, v15
v_cvt_pk_bf16_f32 v192, v32, v33
v_lshlrev_b32 v32, 16, v192
v_and_b32 v33, s84, v192
v_cvt_pk_bf16_f32 v193, v34, v35
v_lshlrev_b32 v34, 16, v193
v_and_b32 v35, s84, v193
v_cvt_pk_bf16_f32 v194, v36, v37
v_lshlrev_b32 v36, 16, v194
v_and_b32 v37, s84, v194
v_cvt_pk_bf16_f32 v195, v38, v39
v_lshlrev_b32 v38, 16, v195
v_and_b32 v39, s84, v195
s_waitcnt lgkmcnt(0)
s_mul_i32 s6, s6, 1664525
s_add_u32 s6, s6, 1013904223
v_mov_b32 v6, s6
v_lshrrev_b32 v10, 5, v1
v_lshlrev_b32 v10, 8, v10
v_and_b32 v11, 7, v1
v_lshl_add_u32 v10, v11, 5, v10
v_and_b32 v11, 16, v1
v_add_u32 v10, v10, v11
s_lshl_b32 s7, s3, 9
v_add_u32 v7, s7, v10
s_waitcnt vmcnt(17)
v_lshlrev_b32 v192, 16, v224
v_and_b32 v193, s84, v224
v_lshlrev_b32 v194, 16, v225
v_and_b32 v195, s84, v225
v_lshlrev_b32 v196, 16, v226
v_and_b32 v197, s84, v226
v_lshlrev_b32 v198, 16, v227
v_and_b32 v199, s84, v227
v_pk_mul_f32 v[16:17], v[192:193], v[32:33] op_sel:[0,0] op_sel_hi:[1,0]
v_pk_mul_f32 v[18:19], v[194:195], v[32:33] op_sel:[0,0] op_sel_hi:[1,0]
v_pk_mul_f32 v[20:21], v[196:197], v[32:33] op_sel:[0,0] op_sel_hi:[1,0]
v_pk_mul_f32 v[22:23], v[198:199], v[32:33] op_sel:[0,0] op_sel_hi:[1,0]
v_pk_mul_f32 v[24:25], v[192:193], v[36:37] op_sel:[0,0] op_sel_hi:[1,0]
v_pk_mul_f32 v[26:27], v[194:195], v[36:37] op_sel:[0,0] op_sel_hi:[1,0]
v_pk_mul_f32 v[28:29], v[196:197], v[36:37] op_sel:[0,0] op_sel_hi:[1,0]
v_pk_mul_f32 v[30:31], v[198:199], v[36:37] op_sel:[0,0] op_sel_hi:[1,0]
s_waitcnt vmcnt(16)
v_lshlrev_b32 v192, 16, v228
v_and_b32 v193, s84, v228
v_lshlrev_b32 v194, 16, v229
v_and_b32 v195, s84, v229
v_lshlrev_b32 v196, 16, v230
v_and_b32 v197, s84, v230
v_lshlrev_b32 v198, 16, v231
v_and_b32 v199, s84, v231
v_pk_fma_f32 v[16:17], v[192:193], v[32:33], v[16:17] op_sel:[0,1,0] op_sel_hi:[1,1,1]
v_pk_fma_f32 v[18:19], v[194:195], v[32:33], v[18:19] op_sel:[0,1,0] op_sel_hi:[1,1,1]
v_pk_fma_f32 v[20:21], v[196:197], v[32:33], v[20:21] op_sel:[0,1,0] op_sel_hi:[1,1,1]
v_pk_fma_f32 v[22:23], v[198:199], v[32:33], v[22:23] op_sel:[0,1,0] op_sel_hi:[1,1,1]
v_pk_fma_f32 v[24:25], v[192:193], v[36:37], v[24:25] op_sel:[0,1,0] op_sel_hi:[1,1,1]
v_pk_fma_f32 v[26:27], v[194:195], v[36:37], v[26:27] op_sel:[0,1,0] op_sel_hi:[1,1,1]
v_pk_fma_f32 v[28:29], v[196:197], v[36:37], v[28:29] op_sel:[0,1,0] op_sel_hi:[1,1,1]
v_pk_fma_f32 v[30:31], v[198:199], v[36:37], v[30:31] op_sel:[0,1,0] op_sel_hi:[1,1,1]
s_waitcnt vmcnt(15)
v_lshlrev_b32 v192, 16, v232
v_and_b32 v193, s84, v232
v_lshlrev_b32 v194, 16, v233
v_and_b32 v195, s84, v233
v_lshlrev_b32 v196, 16, v234
v_and_b32 v197, s84, v234
v_lshlrev_b32 v198, 16, v235
v_and_b32 v199, s84, v235
v_pk_fma_f32 v[16:17], v[192:193], v[34:35], v[16:17] op_sel:[0,0,0] op_sel_hi:[1,0,1]
v_pk_fma_f32 v[18:19], v[194:195], v[34:35], v[18:19] op_sel:[0,0,0] op_sel_hi:[1,0,1]
v_pk_fma_f32 v[20:21], v[196:197], v[34:35], v[20:21] op_sel:[0,0,0] op_sel_hi:[1,0,1]
v_pk_fma_f32 v[22:23], v[198:199], v[34:35], v[22:23] op_sel:[0,0,0] op_sel_hi:[1,0,1]
v_pk_fma_f32 v[24:25], v[192:193], v[38:39], v[24:25] op_sel:[0,0,0] op_sel_hi:[1,0,1]
v_pk_fma_f32 v[26:27], v[194:195], v[38:39], v[26:27] op_sel:[0,0,0] op_sel_hi:[1,0,1]
v_pk_fma_f32 v[28:29], v[196:197], v[38:39], v[28:29] op_sel:[0,0,0] op_sel_hi:[1,0,1]
v_pk_fma_f32 v[30:31], v[198:199], v[38:39], v[30:31] op_sel:[0,0,0] op_sel_hi:[1,0,1]
s_waitcnt vmcnt(14)
v_lshlrev_b32 v192, 16, v236
v_and_b32 v193, s84, v236
v_lshlrev_b32 v194, 16, v237
v_and_b32 v195, s84, v237
v_lshlrev_b32 v196, 16, v238
v_and_b32 v197, s84, v238
v_lshlrev_b32 v198, 16, v239
v_and_b32 v199, s84, v239
v_pk_fma_f32 v[16:17], v[192:193], v[34:35], v[16:17] op_sel:[0,1,0] op_sel_hi:[1,1,1]
v_pk_fma_f32 v[18:19], v[194:195], v[34:35], v[18:19] op_sel:[0,1,0] op_sel_hi:[1,1,1]
v_pk_fma_f32 v[20:21], v[196:197], v[34:35], v[20:21] op_sel:[0,1,0] op_sel_hi:[1,1,1]
v_pk_fma_f32 v[22:23], v[198:199], v[34:35], v[22:23] op_sel:[0,1,0] op_sel_hi:[1,1,1]
v_pk_fma_f32 v[24:25], v[192:193], v[38:39], v[24:25] op_sel:[0,1,0] op_sel_hi:[1,1,1]
v_pk_fma_f32 v[26:27], v[194:195], v[38:39], v[26:27] op_sel:[0,1,0] op_sel_hi:[1,1,1]
v_pk_fma_f32 v[28:29], v[196:197], v[38:39], v[28:29] op_sel:[0,1,0] op_sel_hi:[1,1,1]
v_pk_fma_f32 v[30:31], v[198:199], v[38:39], v[30:31] op_sel:[0,1,0] op_sel_hi:[1,1,1]
v_permlane32_swap_b32 v16, v24
v_permlane32_swap_b32 v17, v25
v_permlane32_swap_b32 v18, v26
v_permlane32_swap_b32 v19, v27
v_permlane32_swap_b32 v20, v28
v_permlane32_swap_b32 v21, v29
v_permlane32_swap_b32 v22, v30
v_permlane32_swap_b32 v23, v31
v_add_f32 v16, v16, v24
v_add_f32 v17, v17, v25
v_add_f32 v18, v18, v26
v_add_f32 v19, v19, v27
v_add_f32 v20, v20, v28
v_add_f32 v21, v21, v29
v_add_f32 v22, v22, v30
v_add_f32 v23, v23, v31
v_permlane16_swap_b32 v16, v20
v_permlane16_swap_b32 v17, v21
v_permlane16_swap_b32 v18, v22
v_permlane16_swap_b32 v19, v23
v_add_f32 v16, v16, v20
v_add_f32 v17, v17, v21
v_add_f32 v18, v18, v22
v_add_f32 v19, v19, v23
v_add_f32_dpp v16, v16, v16 row_ror:8 row_mask:0xf bank_mask:0xf
v_add_f32_dpp v17, v17, v17 row_ror:8 row_mask:0xf bank_mask:0xf
v_add_f32_dpp v18, v18, v18 row_ror:8 row_mask:0xf bank_mask:0xf
v_add_f32_dpp v19, v19, v19 row_ror:8 row_mask:0xf bank_mask:0xf
ds_write_b128 v7, v[16:19] offset:0
s_lshl_b32 s7, s3, 2
v_mov_b32 v11, s7
s_waitcnt lgkmcnt(0)
s_mov_b64 exec, 1
v_mov_b32 v12, 1
ds_write_b32 v11, v12 offset:11008
s_mov_b64 exec, -1
s_cmp_lg_u32 s3, 7
s_cbranch_scc1 L_skip_1
v_and_b32 v11, 7, v1
v_lshlrev_b32 v11, 2, v11
s_mov_b32 s15, 0
L_wfa_2:
ds_read_b32 v12, v11 offset:11008
s_add_u32 s15, s15, 1
s_cmp_gt_u32 s15, 524288
s_waitcnt lgkmcnt(0)
s_cbranch_scc1 L_wfax_3
v_cmp_ne_u32 vcc, 1, v12
s_cbranch_vccnz L_wfa_2
L_wfax_3:
s_mov_b32 exec_hi, 0
ds_read_b128 v[192:195], v3 offset:0
ds_read_b128 v[196:199], v3 offset:512
ds_read_b128 v[200:203], v3 offset:1024
ds_read_b128 v[204:207], v3 offset:1536
ds_read_b128 v[208:211], v3 offset:2048
ds_read_b128 v[212:215], v3 offset:2560
ds_read_b128 v[216:219], v3 offset:3072
ds_read_b128 v[220:223], v3 offset:3584
v_lshrrev_b32 v10, 4, v1
v_mul_u32_u24 v10, 30720, v10
v_and_b32 v11, 15, v1
v_lshl_add_u32 v10, v11, 4, v10
s_and_b32 s7, s2, 3
s_mul_i32 s7, s7, 61440
s_lshr_b32 s72, s2, 2
s_lshl_b32 s72, s72, 8
s_add_u32 s72, s72, 4096
s_add_u32 s7, s7, s72
s_waitcnt lgkmcnt(0)
v_pk_add_f32 v[192:193], v[192:193], v[196:197]
v_pk_add_f32 v[194:195], v[194:195], v[198:199]
v_pk_add_f32 v[192:193], v[192:193], v[200:201]
v_pk_add_f32 v[194:195], v[194:195], v[202:203]
v_pk_add_f32 v[192:193], v[192:193], v[204:205]
v_pk_add_f32 v[194:195], v[194:195], v[206:207]
v_pk_add_f32 v[192:193], v[192:193], v[208:209]
v_pk_add_f32 v[194:195], v[194:195], v[210:211]
v_pk_add_f32 v[192:193], v[192:193], v[212:213]
v_pk_add_f32 v[194:195], v[194:195], v[214:215]
v_pk_add_f32 v[192:193], v[192:193], v[216:217]
v_pk_add_f32 v[194:195], v[194:195], v[218:219]
v_pk_add_f32 v[192:193], v[192:193], v[220:221]
v_pk_add_f32 v[194:195], v[194:195], v[222:223]
v_add_u32 v192, 0x80, v192
v_add_u32 v193, 0x80, v193
v_add_u32 v194, 0x80, v194
v_add_u32 v195, 0x80, v195
v_perm_b32 v196, v192, v6, s10
v_perm_b32 v197, v193, v6, s11
v_perm_b32 v198, v194, v6, s12
v_perm_b32 v199, v195, v6, s13
buffer_store_dwordx4 v[196:199], v10, s[56:59], s7 offen sc1
s_mov_b64 exec, -1
L_skip_1:
s_setprio 2
s_lshr_b32 s7, s2, 5
s_lshl_b32 s7, s7, 2
s_and_b32 s27, s3, 3
s_add_u32 s7, s7, s27
s_lshl_b32 s7, s7, 8
s_add_u32 s7, s7, 327680
s_add_u32 s92, s56, s7
s_addc_u32 s93, s57, 0
s_and_b32 s72, s2, 31
s_lshr_b32 s73, s3, 2
s_or_b32 s72, s72, s73
s_cmp_lg_u32 s72, 0
s_cbranch_scc1 L_skip_4
s_mov_b64 exec, 1
v_mov_b32 v200, 0
v_mov_b32 v201, s6
buffer_store_dwordx2 v[200:201], off, s[56:59], s7 sc1
s_mov_b64 exec, -1
L_skip_4:
s_waitcnt vmcnt(11)
v_lshlrev_b32 v192, 16, v240
v_and_b32 v193, s84, v240
v_lshlrev_b32 v194, 16, v241
v_and_b32 v195, s84, v241
v_lshlrev_b32 v196, 16, v242
v_and_b32 v197, s84, v242
v_lshlrev_b32 v198, 16, v243
v_and_b32 v199, s84, v243
v_pk_mul_f32 v[16:17], v[192:193], v[32:33] op_sel:[0,0] op_sel_hi:[1,0]
v_pk_mul_f32 v[18:19], v[194:195], v[32:33] op_sel:[0,0] op_sel_hi:[1,0]
v_pk_mul_f32 v[20:21], v[196:197], v[32:33] op_sel:[0,0] op_sel_hi:[1,0]
v_pk_mul_f32 v[22:23], v[198:199], v[32:33] op_sel:[0,0] op_sel_hi:[1,0]
v_pk_mul_f32 v[24:25], v[192:193], v[36:37] op_sel:[0,0] op_sel_hi:[1,0]
v_pk_mul_f32 v[26:27], v[194:195], v[36:37] op_sel:[0,0] op_sel_hi:[1,0]
v_pk_mul_f32 v[28:29], v[196:197], v[36:37] op_sel:[0,0] op_sel_hi:[1,0]
v_pk_mul_f32 v[30:31], v[198:199], v[36:37] op_sel:[0,0] op_sel_hi:[1,0]
s_add_u32 s75, s68, 0
s_waitcnt vmcnt(4)
buffer_load_dwordx4 v[128:131], v3, s[44:47], s75 offen offset:0 nt
s_waitcnt vmcnt(11)
v_lshlrev_b32 v192, 16, v244
v_and_b32 v193, s84, v244
v_lshlrev_b32 v194, 16, v245
v_and_b32 v195, s84, v245
v_lshlrev_b32 v196, 16, v246
v_and_b32 v197, s84, v246
v_lshlrev_b32 v198, 16, v247
v_and_b32 v199, s84, v247
v_pk_fma_f32 v[16:17], v[192:193], v[32:33], v[16:17] op_sel:[0,1,0] op_sel_hi:[1,1,1]
v_pk_fma_f32 v[18:19], v[194:195], v[32:33], v[18:19] op_sel:[0,1,0] op_sel_hi:[1,1,1]
v_pk_fma_f32 v[20:21], v[196:197], v[32:33], v[20:21] op_sel:[0,1,0] op_sel_hi:[1,1,1]
v_pk_fma_f32 v[22:23], v[198:199], v[32:33], v[22:23] op_sel:[0,1,0] op_sel_hi:[1,1,1]
v_pk_fma_f32 v[24:25], v[192:193], v[36:37], v[24:25] op_sel:[0,1,0] op_sel_hi:[1,1,1]
v_pk_fma_f32 v[26:27], v[194:195], v[36:37], v[26:27] op_sel:[0,1,0] op_sel_hi:[1,1,1]
v_pk_fma_f32 v[28:29], v[196:197], v[36:37], v[28:29] op_sel:[0,1,0] op_sel_hi:[1,1,1]
v_pk_fma_f32 v[30:31], v[198:199], v[36:37], v[30:31] op_sel:[0,1,0] op_sel_hi:[1,1,1]
s_waitcnt vmcnt(4)
buffer_load_dwordx4 v[132:135], v3, s[44:47], s75 offen offset:1024 nt
s_waitcnt vmcnt(11)
v_lshlrev_b32 v192, 16, v248
v_and_b32 v193, s84, v248
v_lshlrev_b32 v194, 16, v249
v_and_b32 v195, s84, v249
v_lshlrev_b32 v196, 16, v250
v_and_b32 v197, s84, v250
v_lshlrev_b32 v198, 16, v251
v_and_b32 v199, s84, v251
v_pk_fma_f32 v[16:17], v[192:193], v[34:35], v[16:17] op_sel:[0,0,0] op_sel_hi:[1,0,1]
v_pk_fma_f32 v[18:19], v[194:195], v[34:35], v[18:19] op_sel:[0,0,0] op_sel_hi:[1,0,1]
v_pk_fma_f32 v[20:21], v[196:197], v[34:35], v[20:21] op_sel:[0,0,0] op_sel_hi:[1,0,1]
v_pk_fma_f32 v[22:23], v[198:199], v[34:35], v[22:23] op_sel:[0,0,0] op_sel_hi:[1,0,1]
v_pk_fma_f32 v[24:25], v[192:193], v[38:39], v[24:25] op_sel:[0,0,0] op_sel_hi:[1,0,1]
v_pk_fma_f32 v[26:27], v[194:195], v[38:39], v[26:27] op_sel:[0,0,0] op_sel_hi:[1,0,1]
v_pk_fma_f32 v[28:29], v[196:197], v[38:39], v[28:29] op_sel:[0,0,0] op_sel_hi:[1,0,1]
v_pk_fma_f32 v[30:31], v[198:199], v[38:39], v[30:31] op_sel:[0,0,0] op_sel_hi:[1,0,1]
s_waitcnt vmcnt(4)
buffer_load_dwordx4 v[136:139], v3, s[44:47], s75 offen offset:2048 nt
s_waitcnt vmcnt(11)
v_lshlrev_b32 v192, 16, v252
v_and_b32 v193, s84, v252
v_lshlrev_b32 v194, 16, v253
v_and_b32 v195, s84, v253
v_lshlrev_b32 v196, 16, v254
v_and_b32 v197, s84, v254
v_lshlrev_b32 v198, 16, v255
v_and_b32 v199, s84, v255
v_pk_fma_f32 v[16:17], v[192:193], v[34:35], v[16:17] op_sel:[0,1,0] op_sel_hi:[1,1,1]
v_pk_fma_f32 v[18:19], v[194:195], v[34:35], v[18:19] op_sel:[0,1,0] op_sel_hi:[1,1,1]
v_pk_fma_f32 v[20:21], v[196:197], v[34:35], v[20:21] op_sel:[0,1,0] op_sel_hi:[1,1,1]
v_pk_fma_f32 v[22:23], v[198:199], v[34:35], v[22:23] op_sel:[0,1,0] op_sel_hi:[1,1,1]
v_pk_fma_f32 v[24:25], v[192:193], v[38:39], v[24:25] op_sel:[0,1,0] op_sel_hi:[1,1,1]
v_pk_fma_f32 v[26:27], v[194:195], v[38:39], v[26:27] op_sel:[0,1,0] op_sel_hi:[1,1,1]
v_pk_fma_f32 v[28:29], v[196:197], v[38:39], v[28:29] op_sel:[0,1,0] op_sel_hi:[1,1,1]
v_pk_fma_f32 v[30:31], v[198:199], v[38:39], v[30:31] op_sel:[0,1,0] op_sel_hi:[1,1,1]
s_waitcnt vmcnt(4)
buffer_load_dwordx4 v[140:143], v3, s[44:47], s75 offen offset:3072 nt
v_permlane32_swap_b32 v16, v24
v_permlane32_swap_b32 v17, v25
v_permlane32_swap_b32 v18, v26
v_permlane32_swap_b32 v19, v27
v_permlane32_swap_b32 v20, v28
v_permlane32_swap_b32 v21, v29
v_permlane32_swap_b32 v22, v30
v_permlane32_swap_b32 v23, v31
v_add_f32 v16, v16, v24
v_add_f32 v17, v17, v25
v_add_f32 v18, v18, v26
v_add_f32 v19, v19, v27
v_add_f32 v20, v20, v28
v_add_f32 v21, v21, v29
v_add_f32 v22, v22, v30
v_add_f32 v23, v23, v31
v_permlane16_swap_b32 v16, v20
v_permlane16_swap_b32 v17, v21
v_permlane16_swap_b32 v18, v22
v_permlane16_swap_b32 v19, v23
v_add_f32 v16, v16, v20
v_add_f32 v17, v17, v21
v_add_f32 v18, v18, v22
v_add_f32 v19, v19, v23
v_add_f32_dpp v16, v16, v16 row_ror:8 row_mask:0xf bank_mask:0xf
v_add_f32_dpp v17, v17, v17 row_ror:8 row_mask:0xf bank_mask:0xf
v_add_f32_dpp v18, v18, v18 row_ror:8 row_mask:0xf bank_mask:0xf
v_add_f32_dpp v19, v19, v19 row_ror:8 row_mask:0xf bank_mask:0xf
ds_write_b128 v7, v[16:19] offset:4096
s_lshl_b32 s7, s3, 2
v_mov_b32 v11, s7
s_waitcnt lgkmcnt(0)
s_mov_b64 exec, 1
v_mov_b32 v12, 1
ds_write_b32 v11, v12 offset:11040
s_mov_b64 exec, -1
v_lshrrev_b32 v10, 4, v1
v_lshlrev_b32 v5, 12, v10
v_and_b32 v11, 15, v1
v_lshl_add_u32 v5, v11, 4, v5
s_add_u32 s75, s68, 32768
s_waitcnt vmcnt(4)
buffer_load_dwordx4 v[144:147], v3, s[44:47], s75 offen offset:0 nt
s_waitcnt vmcnt(4)
buffer_load_dwordx4 v[148:151], v3, s[44:47], s75 offen offset:1024 nt
s_waitcnt vmcnt(4)
buffer_load_dwordx4 v[152:155], v3, s[44:47], s75 offen offset:2048 nt
s_waitcnt vmcnt(4)
buffer_load_dwordx4 v[156:159], v3, s[44:47], s75 offen offset:3072 nt
s_cmp_lg_u32 s3, 6
s_cbranch_scc1 L_skip_5
s_cmp_eq_u32 s86, 0
s_cbranch_scc1 L_skip_5
v_and_b32 v11, 7, v1
v_lshlrev_b32 v11, 2, v11
s_mov_b32 s15, 0
L_wfh_6:
ds_read_b32 v12, v11 offset:11040
s_add_u32 s15, s15, 1
s_cmp_gt_u32 s15, 524288
s_waitcnt lgkmcnt(0)
s_cbranch_scc1 L_wfhx_7
v_cmp_ne_u32 vcc, 1, v12
s_cbranch_vccnz L_wfh_6
L_wfhx_7:
s_mov_b32 exec_hi, 0
ds_read_b128 v[192:195], v3 offset:4096
ds_read_b128 v[196:199], v3 offset:4608
ds_read_b128 v[200:203], v3 offset:5120
ds_read_b128 v[204:207], v3 offset:5632
ds_read_b128 v[208:211], v3 offset:6144
ds_read_b128 v[212:215], v3 offset:6656
ds_read_b128 v[216:219], v3 offset:7168
ds_read_b128 v[220:223], v3 offset:7680
v_lshrrev_b32 v10, 4, v1
v_mul_u32_u24 v10, 30720, v10
v_and_b32 v11, 15, v1
v_lshl_add_u32 v10, v11, 4, v10
s_and_b32 s7, s2, 3
s_mul_i32 s7, s7, 61440
s_lshl_b32 s72, s39, 8
s_add_u32 s72, s72, 20480
s_add_u32 s7, s7, s72
s_waitcnt lgkmcnt(0)
v_pk_add_f32 v[192:193], v[192:193], v[196:197]
v_pk_add_f32 v[194:195], v[194:195], v[198:199]
v_pk_add_f32 v[192:193], v[192:193], v[200:201]
v_pk_add_f32 v[194:195], v[194:195], v[202:203]
v_pk_add_f32 v[192:193], v[192:193], v[204:205]
v_pk_add_f32 v[194:195], v[194:195], v[206:207]
v_pk_add_f32 v[192:193], v[192:193], v[208:209]
v_pk_add_f32 v[194:195], v[194:195], v[210:211]
v_pk_add_f32 v[192:193], v[192:193], v[212:213]
v_pk_add_f32 v[194:195], v[194:195], v[214:215]
v_pk_add_f32 v[192:193], v[192:193], v[216:217]
v_pk_add_f32 v[194:195], v[194:195], v[218:219]
v_pk_add_f32 v[192:193], v[192:193], v[220:221]
v_pk_add_f32 v[194:195], v[194:195], v[222:223]
v_add_u32 v192, 0x80, v192
v_add_u32 v193, 0x80, v193
v_add_u32 v194, 0x80, v194
v_add_u32 v195, 0x80, v195
v_perm_b32 v196, v192, v6, s10
v_perm_b32 v197, v193, v6, s11
v_perm_b32 v198, v194, v6, s12
v_perm_b32 v199, v195, v6, s13
buffer_store_dwordx4 v[196:199], v10, s[56:59], s7 offen sc1
s_mov_b64 exec, -1
L_skip_5:
s_add_u32 s74, s68, 65536
s_waitcnt vmcnt(4)
buffer_load_dwordx4 v[160:163], v2, s[40:43], s74 offen offset:0 nt
s_waitcnt vmcnt(4)
buffer_load_dwordx4 v[164:167], v2, s[40:43], s74 offen offset:128 nt
s_waitcnt vmcnt(4)
buffer_load_dwordx4 v[168:171], v2, s[40:43], s74 offen offset:2048 nt
s_waitcnt vmcnt(4)
buffer_load_dwordx4 v[172:175], v2, s[40:43], s74 offen offset:2176 nt
s_add_u32 s74, s68, 98304
s_waitcnt vmcnt(4)
buffer_load_dwordx4 v[176:179], v2, s[40:43], s74 offen offset:0 nt
s_waitcnt vmcnt(4)
buffer_load_dwordx4 v[180:183], v2, s[40:43], s74 offen offset:128 nt
s_waitcnt vmcnt(4)
buffer_load_dwordx4 v[184:187], v2, s[40:43], s74 offen offset:2048 nt
s_waitcnt vmcnt(4)
buffer_load_dwordx4 v[188:191], v2, s[40:43], s74 offen offset:2176 nt
s_add_u32 s75, s68, 65536
s_waitcnt vmcnt(4)
buffer_load_dwordx4 v[192:195], v3, s[44:47], s75 offen offset:0 nt
s_waitcnt vmcnt(4)
buffer_load_dwordx4 v[196:199], v3, s[44:47], s75 offen offset:1024 nt
s_waitcnt vmcnt(4)
buffer_load_dwordx4 v[200:203], v3, s[44:47], s75 offen offset:2048 nt
s_waitcnt vmcnt(4)
buffer_load_dwordx4 v[204:207], v3, s[44:47], s75 offen offset:3072 nt
s_setprio 1
s_lshr_b32 s77, s2, 7
s_mul_i32 s77, s77, 30720
s_lshr_b32 s7, s2, 5
s_and_b32 s7, s7, 3
s_lshl_b32 s7, s7, 12
s_add_u32 s77, s77, s7
s_lshl_b32 s7, s3, 10
s_add_u32 s77, s77, s7
s_add_u32 s77, s77, 4096
s_add_u32 s78, s77, 122880
v_add_u32 v48, 61440, v3
v_lshrrev_b32 v10, 3, v1
v_mul_u32_u24 v49, 30720, v10
v_and_b32 v11, 7, v1
v_lshl_add_u32 v49, v11, 4, v49
s_lshl_b32 s79, s87, 7
s_add_u32 s79, s79, 20480
s_cmp_ge_u32 s3, 4
s_cbranch_scc1 L_skip_8
buffer_load_dwordx4 v[64:67], v3, s[56:59], s77 offen sc1
buffer_load_dwordx4 v[68:71], v48, s[56:59], s77 offen sc1
buffer_load_dwordx4 v[72:75], v3, s[56:59], s78 offen sc1
buffer_load_dwordx4 v[76:79], v48, s[56:59], s78 offen sc1
L_skip_8:
s_cmp_lg_u32 s3, 4
s_cbranch_scc1 L_skip_9
s_cmp_eq_u32 s85, 0
s_cbranch_scc1 L_skip_9
buffer_load_dwordx4 v[64:67], v49, s[56:59], s79 offen sc1
L_skip_9:
s_add_u32 s75, s68, 98304
s_waitcnt vmcnt(4)
buffer_load_dwordx4 v[208:211], v3, s[44:47], s75 offen offset:0 nt
s_waitcnt vmcnt(4)
buffer_load_dwordx4 v[212:215], v3, s[44:47], s75 offen offset:1024 nt
s_waitcnt vmcnt(4)
buffer_load_dwordx4 v[216:219], v3, s[44:47], s75 offen offset:2048 nt
s_waitcnt vmcnt(4)
buffer_load_dwordx4 v[220:223], v3, s[44:47], s75 offen offset:3072 nt
s_cmp_ge_u32 s3, 4
s_cbranch_scc1 L_skip_10
s_waitcnt vmcnt(4)
v_perm_b32 v13, v65, v64, s14
v_perm_b32 v14, v67, v66, s14
v_perm_b32 v13, v14, v13, s8
v_xor_b32 v15, v13, v6
v_perm_b32 v13, v69, v68, s14
v_perm_b32 v14, v71, v70, s14
v_perm_b32 v13, v14, v13, s8
v_xor_b32 v13, v13, v6
v_or_b32 v15, v15, v13
v_perm_b32 v13, v73, v72, s14
v_perm_b32 v14, v75, v74, s14
v_perm_b32 v13, v14, v13, s8
v_xor_b32 v13, v13, v6
v_or_b32 v15, v15, v13
v_perm_b32 v13, v77, v76, s14
v_perm_b32 v14, v79, v78, s14
v_perm_b32 v13, v14, v13, s8
v_xor_b32 v13, v13, v6
v_or_b32 v15, v15, v13
s_nop 1
v_or_b32_dpp v15, v15, v15 quad_perm:[1,0,3,2] row_mask:0xf bank_mask:0xf
s_nop 1
v_or_b32_dpp v15, v15, v15 quad_perm:[2,3,0,1] row_mask:0xf bank_mask:0xf
v_cmp_ne_u32 vcc, 0, v15
s_cbranch_vccz L_q_done_12
s_mov_b32 s15, 0
s_mov_b64 s[80:81], exec
L_q_retry_11:
s_mov_b64 exec, vcc
s_nop 4
buffer_load_dwordx4 v[64:67], v3, s[56:59], s77 offen sc1
buffer_load_dwordx4 v[68:71], v48, s[56:59], s77 offen sc1
buffer_load_dwordx4 v[72:75], v3, s[56:59], s78 offen sc1
buffer_load_dwordx4 v[76:79], v48, s[56:59], s78 offen sc1
s_add_u32 s15, s15, 1
s_cmp_gt_u32 s15, 131072
s_waitcnt vmcnt(0)
s_cbranch_scc1 L_q_exit_13
v_perm_b32 v13, v65, v64, s14
v_perm_b32 v14, v67, v66, s14
v_perm_b32 v13, v14, v13, s8
v_xor_b32 v15, v13, v6
v_perm_b32 v13, v69, v68, s14
v_perm_b32 v14, v71, v70, s14
v_perm_b32 v13, v14, v13, s8
v_xor_b32 v13, v13, v6
v_or_b32 v15, v15, v13
v_perm_b32 v13, v73, v72, s14
v_perm_b32 v14, v75, v74, s14
v_perm_b32 v13, v14, v13, s8
v_xor_b32 v13, v13, v6
v_or_b32 v15, v15, v13
v_perm_b32 v13, v77, v76, s14
v_perm_b32 v14, v79, v78, s14
v_perm_b32 v13, v14, v13, s8
v_xor_b32 v13, v13, v6
v_or_b32 v15, v15, v13
s_nop 1
v_or_b32_dpp v15, v15, v15 quad_perm:[1,0,3,2] row_mask:0xf bank_mask:0xf
s_nop 1
v_or_b32_dpp v15, v15, v15 quad_perm:[2,3,0,1] row_mask:0xf bank_mask:0xf
v_cmp_ne_u32 vcc, 0, v15
s_cbranch_vccnz L_q_retry_11
L_q_exit_13:
s_mov_b64 exec, s[80:81]
L_q_done_12:
v_and_b32 v64, s23, v64
v_and_b32 v65, s23, v65
v_and_b32 v66, s23, v66
v_and_b32 v67, s23, v67
v_and_b32 v68, s23, v68
v_and_b32 v69, s23, v69
v_and_b32 v70, s23, v70
v_and_b32 v71, s23, v71
v_and_b32 v72, s23, v72
v_and_b32 v73, s23, v73
v_and_b32 v74, s23, v74
v_and_b32 v75, s23, v75
v_and_b32 v76, s23, v76
v_and_b32 v77, s23, v77
v_and_b32 v78, s23, v78
v_and_b32 v79, s23, v79
v_pk_add_f32 v[64:65], v[64:65], v[68:69]
v_pk_add_f32 v[66:67], v[66:67], v[70:71]
v_pk_add_f32 v[64:65], v[64:65], v[72:73]
v_pk_add_f32 v[66:67], v[66:67], v[74:75]
v_pk_add_f32 v[64:65], v[64:65], v[76:77]
v_pk_add_f32 v[66:67], v[66:67], v[78:79]
v_cvt_pk_bf16_f32 v64, v64, v65
v_cvt_pk_bf16_f32 v65, v66, v67
v_lshlrev_b32 v10, 3, v1
s_lshl_b32 s7, s3, 9
v_add_u32 v10, s7, v10
ds_write_b64 v10, v[64:65] offset:8192
s_lshl_b32 s7, s3, 2
v_mov_b32 v11, s7
s_waitcnt lgkmcnt(0)
s_mov_b64 exec, 1
v_mov_b32 v12, 1
ds_write_b32 v11, v12 offset:11072
s_mov_b64 exec, -1
L_skip_10:
s_cmp_lg_u32 s3, 4
s_cbranch_scc1 L_skip_14
s_cmp_eq_u32 s85, 0
s_cbranch_scc1 L_skip_14
s_waitcnt vmcnt(4)
v_perm_b32 v13, v65, v64, s14
v_perm_b32 v14, v67, v66, s14
v_perm_b32 v13, v14, v13, s8
v_xor_b32 v15, v13, v6
s_nop 1
v_or_b32_dpp v15, v15, v15 quad_perm:[1,0,3,2] row_mask:0xf bank_mask:0xf
s_nop 1
v_or_b32_dpp v15, v15, v15 quad_perm:[2,3,0,1] row_mask:0xf bank_mask:0xf
v_cmp_ne_u32 vcc, 0, v15
s_cbranch_vccz L_h_done_16
s_mov_b32 s15, 0
s_mov_b64 s[80:81], exec
L_h_retry_15:
s_mov_b64 exec, vcc
s_nop 4
buffer_load_dwordx4 v[64:67], v49, s[56:59], s79 offen sc1
s_add_u32 s15, s15, 1
s_cmp_gt_u32 s15, 131072
s_waitcnt vmcnt(0)
s_cbranch_scc1 L_h_exit_17
v_perm_b32 v13, v65, v64, s14
v_perm_b32 v14, v67, v66, s14
v_perm_b32 v13, v14, v13, s8
v_xor_b32 v15, v13, v6
s_nop 1
v_or_b32_dpp v15, v15, v15 quad_perm:[1,0,3,2] row_mask:0xf bank_mask:0xf
s_nop 1
v_or_b32_dpp v15, v15, v15 quad_perm:[2,3,0,1] row_mask:0xf bank_mask:0xf
v_cmp_ne_u32 vcc, 0, v15
s_cbranch_vccnz L_h_retry_15
L_h_exit_17:
s_mov_b64 exec, s[80:81]
L_h_done_16:
v_and_b32 v64, s23, v64
v_and_b32 v65, s23, v65
v_and_b32 v66, s23, v66
v_and_b32 v67, s23, v67
v_mov_b32 v68, v64
v_mov_b32 v69, v65
v_mov_b32 v70, v66
v_mov_b32 v71, v67
v_permlane16_swap_b32 v64, v68
v_permlane16_swap_b32 v65, v69
v_permlane16_swap_b32 v66, v70
v_permlane16_swap_b32 v67, v71
v_add_f32 v64, v64, v68
v_add_f32 v65, v65, v69
v_add_f32 v66, v66, v70
v_add_f32 v67, v67, v71
v_mov_b32 v68, v64
v_mov_b32 v69, v65
v_mov_b32 v70, v66
v_mov_b32 v71, v67
v_permlane32_swap_b32 v64, v68
v_permlane32_swap_b32 v65, v69
v_permlane32_swap_b32 v66, v70
v_permlane32_swap_b32 v67, v71
v_add_f32 v64, v64, v68
v_add_f32 v65, v65, v69
v_add_f32 v66, v66, v70
v_add_f32 v67, v67, v71
v_cvt_pk_bf16_f32 v72, v64, v65
v_lshlrev_b32 v64, 16, v72
v_and_b32 v65, s84, v72
v_cvt_pk_bf16_f32 v73, v66, v67
v_lshlrev_b32 v66, 16, v73
v_and_b32 v67, s84, v73
v_mul_f32 v72, s82, v64
v_mul_f32 v73, s82, v65
v_mul_f32 v74, s82, v66
v_mul_f32 v75, s82, v67
v_exp_f32 v72, -v72
v_exp_f32 v73, -v73
v_exp_f32 v74, -v74
v_exp_f32 v75, -v75
v_add_f32 v72, 1.0, v72
v_add_f32 v73, 1.0, v73
v_add_f32 v74, 1.0, v74
v_add_f32 v75, 1.0, v75
v_rcp_f32 v72, v72
v_rcp_f32 v73, v73
v_rcp_f32 v74, v74
v_rcp_f32 v75, v75
v_mul_f32 v64, v64, v72
v_mul_f32 v65, v65, v73
v_mul_f32 v66, v66, v74
v_mul_f32 v67, v67, v75
v_cvt_pk_bf16_f32 v68, v64, v65
v_cvt_pk_bf16_f32 v69, v66, v67
v_and_b32 v10, 1, v1
v_lshlrev_b32 v10, 5, v10
v_bfe_u32 v11, v1, 1, 2
v_lshl_add_u32 v10, v11, 1, v10
v_bfe_u32 v11, v1, 3, 1
v_lshl_add_u32 v10, v11, 6, v10
s_mov_b64 exec, 0xffff
ds_write_b16 v10, v68 offset:10752
ds_write_b16_d16_hi v10, v68 offset:10760
ds_write_b16 v10, v69 offset:10768
ds_write_b16_d16_hi v10, v69 offset:10776
s_mov_b64 exec, -1
s_lshl_b32 s7, s3, 2
v_mov_b32 v11, s7
s_waitcnt lgkmcnt(0)
s_mov_b64 exec, 1
v_mov_b32 v12, 1
ds_write_b32 v11, v12 offset:11072
s_mov_b64 exec, -1
L_skip_14:
v_and_b32 v10, 7, v1
v_lshlrev_b32 v10, 8, v10
v_lshrrev_b32 v11, 4, v1
v_lshl_add_u32 v10, v11, 5, v10
v_bfe_u32 v11, v1, 3, 1
v_lshl_add_u32 v10, v11, 4, v10
v_and_b32 v11, 3, v1
v_lshlrev_b32 v11, 2, v11
s_mov_b32 s15, 0
L_wfq_18:
ds_read_b32 v12, v11 offset:11072
s_add_u32 s15, s15, 1
s_cmp_gt_u32 s15, 524288
s_waitcnt lgkmcnt(0)
s_cbranch_scc1 L_wfqx_19
v_cmp_ne_u32 vcc, 1, v12
s_cbranch_vccnz L_wfq_18
L_wfqx_19:
ds_read_b128 v[48:51], v10 offset:8192
ds_read_b128 v[52:55], v10 offset:8320
s_waitcnt vmcnt(24) lgkmcnt(0)
v_mfma_f32_16x16x32_bf16 v[64:67], v[96:99], v[48:51], 0
v_mfma_f32_16x16x32_bf16 v[68:71], v[104:107], v[48:51], 0
v_mfma_f32_16x16x32_bf16 v[72:75], v[112:115], v[48:51], 0
v_mfma_f32_16x16x32_bf16 v[76:79], v[120:123], v[48:51], 0
v_mfma_f32_16x16x32_bf16 v[64:67], v[100:103], v[52:55], v[64:67]
v_mfma_f32_16x16x32_bf16 v[68:71], v[108:111], v[52:55], v[68:71]
v_mfma_f32_16x16x32_bf16 v[72:75], v[116:119], v[52:55], v[72:75]
v_mfma_f32_16x16x32_bf16 v[76:79], v[124:127], v[52:55], v[76:79]
s_load_dwordx2 s[94:95], s[92:93], 0 glc
s_add_u32 s74, s68, 131072
buffer_load_dwordx4 v[96:99], v2, s[40:43], s74 offen offset:0 nt
buffer_load_dwordx4 v[100:103], v2, s[40:43], s74 offen offset:128 nt
buffer_load_dwordx4 v[104:107], v2, s[40:43], s74 offen offset:2048 nt
buffer_load_dwordx4 v[108:111], v2, s[40:43], s74 offen offset:2176 nt
buffer_load_dwordx4 v[112:115], v3, s[44:47], s74 offen offset:0 nt
buffer_load_dwordx4 v[116:119], v3, s[44:47], s74 offen offset:1024 nt
buffer_load_dwordx4 v[120:123], v3, s[44:47], s74 offen offset:2048 nt
buffer_load_dwordx4 v[124:127], v3, s[44:47], s74 offen offset:3072 nt
v_add_f32_dpp v80, v65, v64 row_ror:8 row_mask:0xf bank_mask:0xf
v_add_f32_dpp v81, v67, v66 row_ror:8 row_mask:0xf bank_mask:0xf
v_add_f32_dpp v82, v69, v68 row_ror:8 row_mask:0xf bank_mask:0xf
v_add_f32_dpp v83, v71, v70 row_ror:8 row_mask:0xf bank_mask:0xf
v_add_f32_dpp v84, v73, v72 row_ror:8 row_mask:0xf bank_mask:0xf
v_add_f32_dpp v85, v75, v74 row_ror:8 row_mask:0xf bank_mask:0xf
v_add_f32_dpp v86, v77, v76 row_ror:8 row_mask:0xf bank_mask:0xf
v_add_f32_dpp v87, v79, v78 row_ror:8 row_mask:0xf bank_mask:0xf
v_cvt_pk_bf16_f32 v88, v80, v81
v_lshlrev_b32 v80, 16, v88
v_and_b32 v81, s84, v88
v_cvt_pk_bf16_f32 v89, v82, v83
v_lshlrev_b32 v82, 16, v89
v_and_b32 v83, s84, v89
v_cvt_pk_bf16_f32 v90, v84, v85
v_lshlrev_b32 v84, 16, v90
v_and_b32 v85, s84, v90
v_cvt_pk_bf16_f32 v91, v86, v87
v_lshlrev_b32 v86, 16, v91
v_and_b32 v87, s84, v91
v_mul_f32 v80, s83, v80
v_mul_f32 v81, s83, v81
v_mul_f32 v82, s83, v82
v_mul_f32 v83, s83, v83
v_mul_f32 v84, s83, v84
v_mul_f32 v85, s83, v85
v_mul_f32 v86, s83, v86
v_mul_f32 v87, s83, v87
v_cvt_pk_bf16_f32 v88, v80, v81
v_lshlrev_b32 v80, 16, v88
v_and_b32 v81, s84, v88
v_cvt_pk_bf16_f32 v89, v82, v83
v_lshlrev_b32 v82, 16, v89
v_and_b32 v83, s84, v89
v_cvt_pk_bf16_f32 v90, v84, v85
v_lshlrev_b32 v84, 16, v90
v_and_b32 v85, s84, v90
v_cvt_pk_bf16_f32 v91, v86, v87
v_lshlrev_b32 v86, 16, v91
v_and_b32 v87, s84, v91
v_max3_f32 v10, v80, v81, v82
v_max3_f32 v11, v83, v84, v85
v_max3_f32 v10, v10, v86, v87
v_max_f32 v10, v10, v11
v_mov_b32 v11, v10
s_nop 1
v_permlane16_swap_b32 v10, v11
v_max_f32 v10, v10, v11
v_mov_b32 v11, v10
s_nop 1
v_permlane32_swap_b32 v10, v11
v_max_f32 v10, v10, v11
v_mul_f32 v10, s82, v10
v_mov_b32 v8, v10
v_fma_f32 v80, v80, s82, -v10
v_fma_f32 v81, v81, s82, -v10
v_fma_f32 v82, v82, s82, -v10
v_fma_f32 v83, v83, s82, -v10
v_fma_f32 v84, v84, s82, -v10
v_fma_f32 v85, v85, s82, -v10
v_fma_f32 v86, v86, s82, -v10
v_fma_f32 v87, v87, s82, -v10
v_exp_f32 v80, v80
v_exp_f32 v81, v81
v_exp_f32 v82, v82
v_exp_f32 v83, v83
v_exp_f32 v84, v84
v_exp_f32 v85, v85
v_exp_f32 v86, v86
v_exp_f32 v87, v87
v_cvt_pk_bf16_f32 v56, v80, v81
v_cvt_pk_bf16_f32 v57, v82, v83
v_cvt_pk_bf16_f32 v58, v84, v85
v_cvt_pk_bf16_f32 v59, v86, v87
v_add_f32 v9, v80, v81
v_add_f32 v9, v9, v82
v_add_f32 v9, v9, v83
v_add_f32 v9, v9, v84
v_add_f32 v9, v9, v85
v_add_f32 v9, v9, v86
v_add_f32 v9, v9, v87
s_waitcnt vmcnt(24)
v_perm_b32 v64, v132, v128, s8
v_perm_b32 v68, v132, v128, s9
v_perm_b32 v72, v133, v129, s8
v_perm_b32 v76, v133, v129, s9
v_perm_b32 v80, v134, v130, s8
v_perm_b32 v84, v134, v130, s9
v_perm_b32 v88, v135, v131, s8
v_perm_b32 v92, v135, v131, s9
v_perm_b32 v65, v140, v136, s8
v_perm_b32 v69, v140, v136, s9
v_perm_b32 v73, v141, v137, s8
v_perm_b32 v77, v141, v137, s9
v_perm_b32 v81, v142, v138, s8
v_perm_b32 v85, v142, v138, s9
v_perm_b32 v89, v143, v139, s8
v_perm_b32 v93, v143, v139, s9
v_perm_b32 v66, v148, v144, s8
v_perm_b32 v70, v148, v144, s9
v_perm_b32 v74, v149, v145, s8
v_perm_b32 v78, v149, v145, s9
v_perm_b32 v82, v150, v146, s8
v_perm_b32 v86, v150, v146, s9
v_perm_b32 v90, v151, v147, s8
v_perm_b32 v94, v151, v147, s9
v_perm_b32 v67, v156, v152, s8
v_perm_b32 v71, v156, v152, s9
v_perm_b32 v75, v157, v153, s8
v_perm_b32 v79, v157, v153, s9
v_perm_b32 v83, v158, v154, s8
v_perm_b32 v87, v158, v154, s9
v_perm_b32 v91, v159, v155, s8
v_perm_b32 v95, v159, v155, s9
v_mfma_f32_16x16x32_bf16 v[16:19], v[64:67], v[56:59], 0
v_mfma_f32_16x16x32_bf16 v[20:23], v[68:71], v[56:59], 0
v_mfma_f32_16x16x32_bf16 v[24:27], v[72:75], v[56:59], 0
v_mfma_f32_16x16x32_bf16 v[28:31], v[76:79], v[56:59], 0
v_mfma_f32_16x16x32_bf16 v[32:35], v[80:83], v[56:59], 0
v_mfma_f32_16x16x32_bf16 v[36:39], v[84:87], v[56:59], 0
v_mfma_f32_16x16x32_bf16 v[40:43], v[88:91], v[56:59], 0
v_mfma_f32_16x16x32_bf16 v[44:47], v[92:95], v[56:59], 0
s_mov_b32 s15, 0
L_ctpoll_20:
s_waitcnt lgkmcnt(0)
s_cmp_eq_u32 s95, s6
s_cbranch_scc1 L_ctok_21
s_add_u32 s15, s15, 1
s_cmp_gt_u32 s15, 131072
s_cbranch_scc1 L_ctok_21
s_load_dwordx2 s[94:95], s[92:93], 0 glc
s_branch L_ctpoll_20
L_ctok_21:
s_waitcnt vmcnt(16)
v_mfma_f32_16x16x32_bf16 v[64:67], v[160:163], v[48:51], 0
v_mfma_f32_16x16x32_bf16 v[68:71], v[168:171], v[48:51], 0
v_mfma_f32_16x16x32_bf16 v[72:75], v[176:179], v[48:51], 0
v_mfma_f32_16x16x32_bf16 v[76:79], v[184:187], v[48:51], 0
v_mfma_f32_16x16x32_bf16 v[64:67], v[164:167], v[52:55], v[64:67]
v_mfma_f32_16x16x32_bf16 v[68:71], v[172:175], v[52:55], v[68:71]
v_mfma_f32_16x16x32_bf16 v[72:75], v[180:183], v[52:55], v[72:75]
v_mfma_f32_16x16x32_bf16 v[76:79], v[188:191], v[52:55], v[76:79]
s_nop 4
v_add_f32_dpp v80, v65, v64 row_ror:8 row_mask:0xf bank_mask:0xf
v_add_f32_dpp v81, v67, v66 row_ror:8 row_mask:0xf bank_mask:0xf
v_add_f32_dpp v82, v69, v68 row_ror:8 row_mask:0xf bank_mask:0xf
v_add_f32_dpp v83, v71, v70 row_ror:8 row_mask:0xf bank_mask:0xf
v_add_f32_dpp v84, v73, v72 row_ror:8 row_mask:0xf bank_mask:0xf
v_add_f32_dpp v85, v75, v74 row_ror:8 row_mask:0xf bank_mask:0xf
v_add_f32_dpp v86, v77, v76 row_ror:8 row_mask:0xf bank_mask:0xf
v_add_f32_dpp v87, v79, v78 row_ror:8 row_mask:0xf bank_mask:0xf
v_cvt_pk_bf16_f32 v88, v80, v81
v_lshlrev_b32 v80, 16, v88
v_and_b32 v81, s84, v88
v_cvt_pk_bf16_f32 v89, v82, v83
v_lshlrev_b32 v82, 16, v89
v_and_b32 v83, s84, v89
v_cvt_pk_bf16_f32 v90, v84, v85
v_lshlrev_b32 v84, 16, v90
v_and_b32 v85, s84, v90
v_cvt_pk_bf16_f32 v91, v86, v87
v_lshlrev_b32 v86, 16, v91
v_and_b32 v87, s84, v91
v_mul_f32 v80, s83, v80
v_mul_f32 v81, s83, v81
v_mul_f32 v82, s83, v82
v_mul_f32 v83, s83, v83
v_mul_f32 v84, s83, v84
v_mul_f32 v85, s83, v85
v_mul_f32 v86, s83, v86
v_mul_f32 v87, s83, v87
v_cvt_pk_bf16_f32 v88, v80, v81
v_lshlrev_b32 v80, 16, v88
v_and_b32 v81, s84, v88
v_cvt_pk_bf16_f32 v89, v82, v83
v_lshlrev_b32 v82, 16, v89
v_and_b32 v83, s84, v89
v_cvt_pk_bf16_f32 v90, v84, v85
v_lshlrev_b32 v84, 16, v90
v_and_b32 v85, s84, v90
v_cvt_pk_bf16_f32 v91, v86, v87
v_lshlrev_b32 v86, 16, v91
v_and_b32 v87, s84, v91
v_max3_f32 v10, v80, v81, v82
v_max3_f32 v11, v83, v84, v85
v_max3_f32 v10, v10, v86, v87
v_max_f32 v10, v10, v11
v_mov_b32 v11, v10
s_nop 1
v_permlane16_swap_b32 v10, v11
v_max_f32 v10, v10, v11
v_mov_b32 v11, v10
s_nop 1
v_permlane32_swap_b32 v10, v11
v_max_f32 v10, v10, v11
v_mul_f32 v10, s82, v10
v_max_f32 v10, v10, v8
v_sub_f32 v7, v8, v10
v_exp_f32 v7, v7
v_mov_b32 v8, v10
v_fma_f32 v80, v80, s82, -v10
v_fma_f32 v81, v81, s82, -v10
v_fma_f32 v82, v82, s82, -v10
v_fma_f32 v83, v83, s82, -v10
v_fma_f32 v84, v84, s82, -v10
v_fma_f32 v85, v85, s82, -v10
v_fma_f32 v86, v86, s82, -v10
v_fma_f32 v87, v87, s82, -v10
v_exp_f32 v80, v80
v_exp_f32 v81, v81
v_exp_f32 v82, v82
v_exp_f32 v83, v83
v_exp_f32 v84, v84
v_exp_f32 v85, v85
v_exp_f32 v86, v86
v_exp_f32 v87, v87
v_mul_f32 v9, v9, v7
v_mul_f32 v16, v16, v7
v_mul_f32 v17, v17, v7
v_mul_f32 v18, v18, v7
v_mul_f32 v19, v19, v7
v_mul_f32 v20, v20, v7
v_mul_f32 v21, v21, v7
v_mul_f32 v22, v22, v7
v_mul_f32 v23, v23, v7
v_mul_f32 v24, v24, v7
v_mul_f32 v25, v25, v7
v_mul_f32 v26, v26, v7
v_mul_f32 v27, v27, v7
v_mul_f32 v28, v28, v7
v_mul_f32 v29, v29, v7
v_mul_f32 v30, v30, v7
v_mul_f32 v31, v31, v7
v_mul_f32 v32, v32, v7
v_mul_f32 v33, v33, v7
v_mul_f32 v34, v34, v7
v_mul_f32 v35, v35, v7
v_mul_f32 v36, v36, v7
v_mul_f32 v37, v37, v7
v_mul_f32 v38, v38, v7
v_mul_f32 v39, v39, v7
v_mul_f32 v40, v40, v7
v_mul_f32 v41, v41, v7
v_mul_f32 v42, v42, v7
v_mul_f32 v43, v43, v7
v_mul_f32 v44, v44, v7
v_mul_f32 v45, v45, v7
v_mul_f32 v46, v46, v7
v_mul_f32 v47, v47, v7
v_cvt_pk_bf16_f32 v56, v80, v81
v_cvt_pk_bf16_f32 v57, v82, v83
v_cvt_pk_bf16_f32 v58, v84, v85
v_cvt_pk_bf16_f32 v59, v86, v87
v_add_f32 v9, v9, v80
v_add_f32 v9, v9, v81
v_add_f32 v9, v9, v82
v_add_f32 v9, v9, v83
v_add_f32 v9, v9, v84
v_add_f32 v9, v9, v85
v_add_f32 v9, v9, v86
v_add_f32 v9, v9, v87
s_waitcnt vmcnt(8)
v_perm_b32 v64, v196, v192, s8
v_perm_b32 v68, v196, v192, s9
v_perm_b32 v72, v197, v193, s8
v_perm_b32 v76, v197, v193, s9
v_perm_b32 v80, v198, v194, s8
v_perm_b32 v84, v198, v194, s9
v_perm_b32 v88, v199, v195, s8
v_perm_b32 v92, v199, v195, s9
v_perm_b32 v65, v204, v200, s8
v_perm_b32 v69, v204, v200, s9
v_perm_b32 v73, v205, v201, s8
v_perm_b32 v77, v205, v201, s9
v_perm_b32 v81, v206, v202, s8
v_perm_b32 v85, v206, v202, s9
v_perm_b32 v89, v207, v203, s8
v_perm_b32 v93, v207, v203, s9
v_perm_b32 v66, v212, v208, s8
v_perm_b32 v70, v212, v208, s9
v_perm_b32 v74, v213, v209, s8
v_perm_b32 v78, v213, v209, s9
v_perm_b32 v82, v214, v210, s8
v_perm_b32 v86, v214, v210, s9
v_perm_b32 v90, v215, v211, s8
v_perm_b32 v94, v215, v211, s9
v_perm_b32 v67, v220, v216, s8
v_perm_b32 v71, v220, v216, s9
v_perm_b32 v75, v221, v217, s8
v_perm_b32 v79, v221, v217, s9
v_perm_b32 v83, v222, v218, s8
v_perm_b32 v87, v222, v218, s9
v_perm_b32 v91, v223, v219, s8
v_perm_b32 v95, v223, v219, s9
v_mfma_f32_16x16x32_bf16 v[16:19], v[64:67], v[56:59], v[16:19]
v_mfma_f32_16x16x32_bf16 v[20:23], v[68:71], v[56:59], v[20:23]
v_mfma_f32_16x16x32_bf16 v[24:27], v[72:75], v[56:59], v[24:27]
v_mfma_f32_16x16x32_bf16 v[28:31], v[76:79], v[56:59], v[28:31]
v_mfma_f32_16x16x32_bf16 v[32:35], v[80:83], v[56:59], v[32:35]
v_mfma_f32_16x16x32_bf16 v[36:39], v[84:87], v[56:59], v[36:39]
v_mfma_f32_16x16x32_bf16 v[40:43], v[88:91], v[56:59], v[40:43]
v_mfma_f32_16x16x32_bf16 v[44:47], v[92:95], v[56:59], v[44:47]
v_and_b32 v10, 15, v1
v_mul_u32_u24 v224, 528, v10
v_lshrrev_b32 v11, 4, v1
v_lshl_add_u32 v224, v11, 7, v224
s_lshl_b32 s7, s3, 12
v_add_u32 v224, s7, v224
v_xor_b32 v225, 16, v224
v_xor_b32 v226, 32, v224
v_xor_b32 v227, 48, v224
v_xor_b32 v228, 64, v224
v_xor_b32 v229, 80, v224
v_xor_b32 v230, 96, v224
v_xor_b32 v231, 112, v224
s_lshl_b32 s7, s3, 6
v_add_u32 v10, s7, v1
v_lshlrev_b32 v233, 4, v10
v_lshrrev_b32 v11, 5, v10
v_and_b32 v11, 7, v11
v_lshlrev_b32 v236, 6, v11
v_lshlrev_b32 v11, 4, v11
v_xor_b32 v232, v233, v11
v_lshlrev_b32 v237, 6, v1
s_lshl_b32 s7, s3, 3
v_add_u32 v237, s7, v237
v_and_b32 v10, 1, v1
v_lshlrev_b32 v10, 6, v10
v_and_b32 v11, 48, v1
v_add_u32 v238, v10, v11
s_and_b32 s7, s3, 1
s_lshl_b32 s7, s7, 6
s_lshr_b32 s78, s3, 1
s_lshl_b32 s78, s78, 5
s_add_u32 s7, s7, s78
v_and_b32 v239, 3, v1
v_lshlrev_b32 v239, 3, v239
v_lshrrev_b32 v10, 4, v1
v_lshl_add_u32 v239, v10, 1, v239
v_add_u32 v239, s7, v239
s_lshr_b32 s7, s5, 5
s_and_b32 s79, s3, 1
s_lshl_b32 s79, s79, 2
s_add_u32 s7, s7, s79
s_lshl_b32 s7, s7, 17
s_lshl_b32 s78, s78, 1
s_add_u32 s78, s78, s7
s_and_b32 s7, s5, 31
s_lshl_b32 s7, s7, 7
s_add_u32 s78, s78, s7
s_add_u32 s78, s78, 524288
s_add_u32 s79, s78, 65536
v_lshrrev_b32 v10, 2, v1
v_and_b32 v11, 3, v1
v_lshlrev_b32 v234, 12, v10
v_lshl_add_u32 v234, v11, 4, v234
s_lshl_b32 s100, s2, 12
s_add_u32 s100, s100, 520192
s_lshl_b32 s101, s2, 7
s_add_u32 s101, s101, 262144
s_lshl_b32 s38, s4, 7
s_add_u32 s38, s38, s87
s_lshl_b32 s38, s38, 13
s_lshl_b32 s7, s3, 10
s_add_u32 s38, s38, s7
s_add_u32 s38, s38, 2097152
v_lshrrev_b32 v242, 2, v1
v_lshlrev_b32 v242, 13, v242
v_and_b32 v243, 3, v1
v_lshlrev_b32 v245, 3, v243
v_lshlrev_b32 v243, 4, v243
v_add_u32 v242, v242, v243
s_lshl_b32 s7, s3, 6
v_add_u32 v244, s7, v243
s_lshl_b32 s16, s5, 6
s_add_u32 s16, s16, 2097152
s_lshl_b32 s7, s3, 17
s_add_u32 s16, s16, s7
s_add_u32 s17, s16, 1048576
s_lshr_b32 s7, s5, 3
s_and_b32 s7, s7, 1
s_lshl_b32 s18, s7, 11
s_lshr_b32 s7, s5, 4
s_lshl_b32 s7, s7, 8
s_add_u32 s18, s18, s7
s_and_b32 s7, s5, 3
s_lshl_b32 s7, s7, 6
s_add_u32 s18, s18, s7
s_and_b32 s7, s5, 4
s_lshl_b32 s7, s7, 1
s_add_u32 s18, s18, s7
s_cmp_lg_u32 s3, 7
s_cselect_b32 s19, s4, 0
s_and_b32 s20, s6, 0xffffff
s_mov_b32 s21, 0x0c040100
s_and_b32 s98, s2, 224
s_lshl_b32 s98, s98, 18
s_add_u32 s98, s98, 163840
s_cmp_lg_u32 s3, 1
s_cbranch_scc1 L_skip_22
s_mov_b64 exec, 1
buffer_load_dword v200, off, s[52:55], s71
buffer_load_dword v201, off, s[56:59], s17
buffer_load_dword v202, off, s[64:67], s18
s_mov_b64 exec, -1
L_skip_22:
s_mov_b32 s96, 1
s_atomic_add s96, s[92:93], 0 glc
s_setprio 0
s_mov_b32 s99, 0
L_loop_23:
s_waitcnt vmcnt(4)
v_mfma_f32_16x16x32_bf16 v[64:67], v[96:99], v[48:51], 0
v_mfma_f32_16x16x32_bf16 v[68:71], v[104:107], v[48:51], 0
v_mfma_f32_16x16x32_bf16 v[64:67], v[100:103], v[52:55], v[64:67]
v_mfma_f32_16x16x32_bf16 v[68:71], v[108:111], v[52:55], v[68:71]
s_waitcnt lgkmcnt(0)
s_and_b32 s74, s96, 31
s_lshl_b32 s74, s74, 18
s_add_u32 s74, s74, s98
s_lshr_b32 s75, s96, 5
s_lshl_b32 s75, s75, 2
s_add_u32 s75, s75, s27
s_lshl_b32 s76, s75, 12
s_lshl_b32 s75, s75, 11
s_add_u32 s75, s75, 32768
s_cmp_lt_u32 s96, 128
s_cselect_b32 s75, s76, s75
s_cselect_b32 s77, 0, 0xff800000
s_cselect_b32 s76, 0, 0x40000000
s_add_u32 s74, s74, s75
s_add_u32 s76, s76, s74
s_cmp_lt_u32 s96, 256
s_cselect_b32 s74, s74, 0x40000000
s_cselect_b32 s75, 1, 0
s_or_b32 s22, s75, s75
s_cbranch_scc1 L_kdn_25
s_add_u32 s22, s71, 0
buffer_load_dwordx4 v[160:163], v5, s[52:55], s22 offen nt
s_add_u32 s22, s71, 16384
buffer_load_dwordx4 v[164:167], v5, s[52:55], s22 offen nt
s_add_u32 s22, s71, 32768
buffer_load_dwordx4 v[168:171], v5, s[52:55], s22 offen nt
s_add_u32 s22, s71, 49152
buffer_load_dwordx4 v[172:175], v5, s[52:55], s22 offen nt
s_branch L_kdn2_26
L_kdn_25:
buffer_load_dwordx4 v[96:99], v2, s[40:43], s74 offen offset:0 nt
buffer_load_dwordx4 v[100:103], v2, s[40:43], s74 offen offset:128 nt
buffer_load_dwordx4 v[104:107], v2, s[40:43], s76 offen offset:2048 nt
buffer_load_dwordx4 v[108:111], v2, s[40:43], s76 offen offset:2176 nt
L_kdn2_26:
v_add_f32_dpp v72, v65, v64 row_ror:8 row_mask:0xf bank_mask:0xf
v_add_f32_dpp v73, v67, v66 row_ror:8 row_mask:0xf bank_mask:0xf
v_add_f32_dpp v74, v69, v68 row_ror:8 row_mask:0xf bank_mask:0xf
v_add_f32_dpp v75, v71, v70 row_ror:8 row_mask:0xf bank_mask:0xf
v_cvt_pk_bf16_f32 v76, v72, v73
v_lshlrev_b32 v72, 16, v76
v_and_b32 v73, s84, v76
v_cvt_pk_bf16_f32 v77, v74, v75
v_lshlrev_b32 v74, 16, v77
v_and_b32 v75, s84, v77
v_mul_f32 v72, s83, v72
v_mul_f32 v73, s83, v73
v_mul_f32 v74, s83, v74
v_mul_f32 v75, s83, v75
v_cvt_pk_bf16_f32 v76, v72, v73
v_lshlrev_b32 v72, 16, v76
v_and_b32 v73, s84, v76
v_cvt_pk_bf16_f32 v77, v74, v75
v_lshlrev_b32 v74, 16, v77
v_and_b32 v75, s84, v77
v_add_f32 v74, s99, v74
v_add_f32 v75, s99, v75
s_mov_b32 s99, s77
v_max3_f32 v10, v72, v73, v74
v_max_f32 v10, v10, v75
v_mov_b32 v11, v10
s_nop 1
v_permlane16_swap_b32 v10, v11
v_max_f32 v10, v10, v11
v_mov_b32 v11, v10
s_nop 1
v_permlane32_swap_b32 v10, v11
v_max_f32 v10, v10, v11
v_mul_f32 v10, s82, v10
v_cmp_gt_f32 vcc, v10, v8
s_and_b64 vcc, vcc, s[88:89]
s_cbranch_scc0 L_noresc_24
v_max_f32 v10, v10, v8
v_sub_f32 v7, v8, v10
v_exp_f32 v7, v7
v_mov_b32 v8, v10
v_mul_f32 v9, v9, v7
v_mul_f32 v16, v16, v7
v_mul_f32 v17, v17, v7
v_mul_f32 v18, v18, v7
v_mul_f32 v19, v19, v7
v_mul_f32 v20, v20, v7
v_mul_f32 v21, v21, v7
v_mul_f32 v22, v22, v7
v_mul_f32 v23, v23, v7
v_mul_f32 v24, v24, v7
v_mul_f32 v25, v25, v7
v_mul_f32 v26, v26, v7
v_mul_f32 v27, v27, v7
v_mul_f32 v28, v28, v7
v_mul_f32 v29, v29, v7
v_mul_f32 v30, v30, v7
v_mul_f32 v31, v31, v7
v_mul_f32 v32, v32, v7
v_mul_f32 v33, v33, v7
v_mul_f32 v34, v34, v7
v_mul_f32 v35, v35, v7
v_mul_f32 v36, v36, v7
v_mul_f32 v37, v37, v7
v_mul_f32 v38, v38, v7
v_mul_f32 v39, v39, v7
v_mul_f32 v40, v40, v7
v_mul_f32 v41, v41, v7
v_mul_f32 v42, v42, v7
v_mul_f32 v43, v43, v7
v_mul_f32 v44, v44, v7
v_mul_f32 v45, v45, v7
v_mul_f32 v46, v46, v7
v_mul_f32 v47, v47, v7
L_noresc_24:
v_fma_f32 v72, v72, s82, -v8
v_fma_f32 v73, v73, s82, -v8
v_fma_f32 v74, v74, s82, -v8
v_fma_f32 v75, v75, s82, -v8
v_exp_f32 v72, v72
v_exp_f32 v73, v73
v_exp_f32 v74, v74
v_exp_f32 v75, v75
v_cvt_pk_bf16_f32 v56, v72, v73
v_cvt_pk_bf16_f32 v57, v74, v75
v_add_f32 v9, v9, v72
v_add_f32 v9, v9, v73
v_add_f32 v9, v9, v74
v_add_f32 v9, v9, v75
s_waitcnt vmcnt(6)
v_perm_b32 v80, v116, v112, s8
v_perm_b32 v82, v116, v112, s9
v_perm_b32 v84, v117, v113, s8
v_perm_b32 v86, v117, v113, s9
v_perm_b32 v88, v118, v114, s8
v_perm_b32 v90, v118, v114, s9
v_perm_b32 v92, v119, v115, s8
v_perm_b32 v94, v119, v115, s9
s_waitcnt vmcnt(4)
v_perm_b32 v81, v124, v120, s8
v_perm_b32 v83, v124, v120, s9
v_perm_b32 v85, v125, v121, s8
v_perm_b32 v87, v125, v121, s9
v_perm_b32 v89, v126, v122, s8
v_perm_b32 v91, v126, v122, s9
v_perm_b32 v93, v127, v123, s8
v_perm_b32 v95, v127, v123, s9
s_cmp_eq_u32 s75, 0
s_cbranch_scc1 L_skip_27
buffer_load_dwordx4 v[112:115], v3, s[44:47], s74 offen offset:0 nt
buffer_load_dwordx4 v[116:119], v3, s[44:47], s74 offen offset:1024 nt
buffer_load_dwordx4 v[120:123], v3, s[44:47], s76 offen offset:2048 nt
buffer_load_dwordx4 v[124:127], v3, s[44:47], s76 offen offset:3072 nt
s_mov_b32 s96, 1
s_atomic_add s96, s[92:93], 0 glc
L_skip_27:
s_or_b32 s22, s75, s4
s_cbranch_scc1 L_skip_28
s_add_u32 s22, s71, 2048
buffer_load_dwordx4 v[176:179], v5, s[52:55], s22 offen nt
s_add_u32 s22, s71, 18432
buffer_load_dwordx4 v[180:183], v5, s[52:55], s22 offen nt
s_add_u32 s22, s71, 34816
buffer_load_dwordx4 v[184:187], v5, s[52:55], s22 offen nt
s_add_u32 s22, s71, 51200
buffer_load_dwordx4 v[188:191], v5, s[52:55], s22 offen nt
L_skip_28:
v_mfma_f32_16x16x16_bf16 v[16:19], v[80:81], v[56:57], v[16:19]
v_mfma_f32_16x16x16_bf16 v[20:23], v[82:83], v[56:57], v[20:23]
v_mfma_f32_16x16x16_bf16 v[24:27], v[84:85], v[56:57], v[24:27]
v_mfma_f32_16x16x16_bf16 v[28:31], v[86:87], v[56:57], v[28:31]
v_mfma_f32_16x16x16_bf16 v[32:35], v[88:89], v[56:57], v[32:35]
v_mfma_f32_16x16x16_bf16 v[36:39], v[90:91], v[56:57], v[36:39]
v_mfma_f32_16x16x16_bf16 v[40:43], v[92:93], v[56:57], v[40:43]
v_mfma_f32_16x16x16_bf16 v[44:47], v[94:95], v[56:57], v[44:47]
s_cmp_lg_u32 s75, 0
s_cbranch_scc1 L_loop_23
v_mov_b32 v11, v9
s_nop 1
v_permlane16_swap_b32 v9, v11
v_add_f32 v9, v9, v11
v_mov_b32 v11, v9
s_nop 1
v_permlane32_swap_b32 v9, v11
v_add_f32 v9, v9, v11
s_mov_b64 exec, 0xff
ds_write_b64 v237, v[8:9] offset:10240
s_mov_b64 exec, s[88:89]
ds_write_b128 v224, v[16:19] offset:12288
ds_write_b128 v225, v[20:23] offset:12288
ds_write_b128 v226, v[24:27] offset:12288
ds_write_b128 v227, v[28:31] offset:12288
ds_write_b128 v228, v[32:35] offset:12288
ds_write_b128 v229, v[36:39] offset:12288
ds_write_b128 v230, v[40:43] offset:12288
ds_write_b128 v231, v[44:47] offset:12288
s_mov_b64 exec, -1
s_waitcnt lgkmcnt(0)
s_barrier
s_cmp_lt_u32 s3, 4
s_cbranch_scc1 L_pubdone_30
ds_read_b128 v[64:67], v236 offset:10240
ds_read_b128 v[68:71], v236 offset:10256
ds_read_b128 v[72:75], v236 offset:10272
ds_read_b128 v[76:79], v236 offset:10288
ds_read_b128 v[16:19], v232 offset:8192
ds_read_b128 v[20:23], v232 offset:12288
ds_read_b128 v[24:27], v232 offset:16384
ds_read_b128 v[28:31], v232 offset:20480
ds_read_b128 v[32:35], v232 offset:24576
ds_read_b128 v[36:39], v232 offset:28672
ds_read_b128 v[40:43], v232 offset:32768
ds_read_b128 v[44:47], v232 offset:36864
s_waitcnt lgkmcnt(8)
v_max3_f32 v10, v64, v66, v68
v_max3_f32 v11, v70, v72, v74
v_max3_f32 v10, v10, v76, v78
v_max_f32 v10, v10, v11
v_sub_f32 v64, v64, v10
v_sub_f32 v66, v66, v10
v_sub_f32 v68, v68, v10
v_sub_f32 v70, v70, v10
v_sub_f32 v72, v72, v10
v_sub_f32 v74, v74, v10
v_sub_f32 v76, v76, v10
v_sub_f32 v78, v78, v10
v_exp_f32 v64, v64
v_exp_f32 v66, v66
v_exp_f32 v68, v68
v_exp_f32 v70, v70
v_exp_f32 v72, v72
v_exp_f32 v74, v74
v_exp_f32 v76, v76
v_exp_f32 v78, v78
v_mul_f32 v12, v65, v64
v_mul_f32 v13, v67, v66
v_fmac_f32 v12, v69, v68
v_fmac_f32 v13, v71, v70
v_fmac_f32 v12, v73, v72
v_fmac_f32 v13, v75, v74
v_fmac_f32 v12, v77, v76
v_fmac_f32 v13, v79, v78
v_add_f32 v12, v12, v13
v_log_f32 v13, v12
v_rcp_f32 v12, v12
s_waitcnt lgkmcnt(7)
v_pk_mul_f32 v[16:17], v[16:17], v[64:65] op_sel_hi:[1,0]
v_pk_mul_f32 v[18:19], v[18:19], v[64:65] op_sel_hi:[1,0]
s_waitcnt lgkmcnt(6)
v_pk_fma_f32 v[16:17], v[20:21], v[66:67], v[16:17] op_sel_hi:[1,0,1]
v_pk_fma_f32 v[18:19], v[22:23], v[66:67], v[18:19] op_sel_hi:[1,0,1]
v_add_f32 v13, v13, v10
v_lshrrev_b32 v13, v245, v13
s_waitcnt lgkmcnt(5)
v_pk_fma_f32 v[16:17], v[24:25], v[68:69], v[16:17] op_sel_hi:[1,0,1]
v_pk_fma_f32 v[18:19], v[26:27], v[68:69], v[18:19] op_sel_hi:[1,0,1]
s_waitcnt lgkmcnt(4)
v_pk_fma_f32 v[16:17], v[28:29], v[70:71], v[16:17] op_sel_hi:[1,0,1]
v_pk_fma_f32 v[18:19], v[30:31], v[70:71], v[18:19] op_sel_hi:[1,0,1]
s_waitcnt lgkmcnt(3)
v_pk_fma_f32 v[16:17], v[32:33], v[72:73], v[16:17] op_sel_hi:[1,0,1]
v_pk_fma_f32 v[18:19], v[34:35], v[72:73], v[18:19] op_sel_hi:[1,0,1]
s_waitcnt lgkmcnt(2)
v_pk_fma_f32 v[16:17], v[36:37], v[74:75], v[16:17] op_sel_hi:[1,0,1]
v_pk_fma_f32 v[18:19], v[38:39], v[74:75], v[18:19] op_sel_hi:[1,0,1]
s_waitcnt lgkmcnt(1)
v_pk_fma_f32 v[16:17], v[40:41], v[76:77], v[16:17] op_sel_hi:[1,0,1]
v_pk_fma_f32 v[18:19], v[42:43], v[76:77], v[18:19] op_sel_hi:[1,0,1]
s_waitcnt lgkmcnt(0)
v_pk_fma_f32 v[16:17], v[44:45], v[78:79], v[16:17] op_sel_hi:[1,0,1]
v_pk_fma_f32 v[18:19], v[46:47], v[78:79], v[18:19] op_sel_hi:[1,0,1]
v_pk_mul_f32 v[16:17], v[16:17], v[12:13] op_sel_hi:[1,0]
v_pk_mul_f32 v[18:19], v[18:19], v[12:13] op_sel_hi:[1,0]
v_perm_b32 v20, v16, v6, s10
v_perm_b32 v21, v17, v6, s11
v_perm_b32 v22, v18, v6, s12
v_perm_b32 v23, v19, v13, s10
buffer_store_dwordx4 v[20:23], v233, s[56:59], s100 offen sc1
L_pubdone_30:
s_cmp_eq_u32 s4, 1
s_cbranch_scc1 L_ftype_31
s_waitcnt vmcnt(0)
v_perm_b32 v128, v164, v160, s8
v_perm_b32 v132, v164, v160, s9
v_perm_b32 v136, v165, v161, s8
v_perm_b32 v140, v165, v161, s9
v_perm_b32 v144, v166, v162, s8
v_perm_b32 v148, v166, v162, s9
v_perm_b32 v152, v167, v163, s8
v_perm_b32 v156, v167, v163, s9
v_perm_b32 v129, v172, v168, s8
v_perm_b32 v133, v172, v168, s9
v_perm_b32 v137, v173, v169, s8
v_perm_b32 v141, v173, v169, s9
v_perm_b32 v145, v174, v170, s8
v_perm_b32 v149, v174, v170, s9
v_perm_b32 v153, v175, v171, s8
v_perm_b32 v157, v175, v171, s9
v_perm_b32 v130, v180, v176, s8
v_perm_b32 v134, v180, v176, s9
v_perm_b32 v138, v181, v177, s8
v_perm_b32 v142, v181, v177, s9
v_perm_b32 v146, v182, v178, s8
v_perm_b32 v150, v182, v178, s9
v_perm_b32 v154, v183, v179, s8
v_perm_b32 v158, v183, v179, s9
v_perm_b32 v131, v188, v184, s8
v_perm_b32 v135, v188, v184, s9
v_perm_b32 v139, v189, v185, s8
v_perm_b32 v143, v189, v185, s9
v_perm_b32 v147, v190, v186, s8
v_perm_b32 v151, v190, v186, s9
v_perm_b32 v155, v191, v187, s8
v_perm_b32 v159, v191, v187, s9
s_cmp_lg_u32 s3, 0
s_cbranch_scc1 L_skip_32
s_mov_b32 exec_lo, 0x01010101
s_mov_b32 exec_hi, 0x01010101
s_mov_b32 s15, 0
L_so_33:
buffer_load_dwordx4 v[32:35], v234, s[56:59], s78 offen sc1
s_add_u32 s15, s15, 1
s_cmp_gt_u32 s15, 131072
s_waitcnt vmcnt(0)
s_cbranch_scc1 L_sox_34
v_perm_b32 v13, v33, v32, s14
v_perm_b32 v13, v34, v13, s21
v_cmp_eq_u32 vcc, s20, v13
s_bcnt1_i32_b64 s7, vcc
s_cmp_ge_u32 s7, 6
s_cbranch_scc1 L_sox_34
s_sleep 1
s_branch L_so_33
L_sox_34:
s_mov_b64 exec, -1
L_skip_32:
s_barrier
s_cmp_ge_u32 s3, 4
s_cbranch_scc1 L_skip_35
buffer_load_dwordx4 v[32:35], v234, s[56:59], s78 offen sc1
buffer_load_dwordx4 v[36:39], v234, s[56:59], s79 offen sc1
s_waitcnt vmcnt(0)
v_perm_b32 v13, v33, v32, s14
v_perm_b32 v14, v37, v36, s14
v_perm_b32 v13, v34, v13, s21
v_perm_b32 v14, v38, v14, s21
v_xor_b32 v13, s20, v13
v_xor_b32 v14, s20, v14
v_or_b32 v15, v13, v14
s_nop 1
v_or_b32_dpp v15, v15, v15 quad_perm:[1,0,3,2] row_mask:0xf bank_mask:0xf
s_nop 1
v_or_b32_dpp v15, v15, v15 quad_perm:[2,3,0,1] row_mask:0xf bank_mask:0xf
v_cmp_ne_u32 vcc, 0, v15
s_cbranch_vccz L_o_done_37
s_mov_b32 s15, 0
s_mov_b64 s[80:81], exec
L_o_retry_36:
s_mov_b64 exec, vcc
s_nop 4
buffer_load_dwordx4 v[32:35], v234, s[56:59], s78 offen sc1
buffer_load_dwordx4 v[36:39], v234, s[56:59], s79 offen sc1
s_add_u32 s15, s15, 1
s_cmp_gt_u32 s15, 131072
s_waitcnt vmcnt(0)
s_cbranch_scc1 L_o_exit_38
v_perm_b32 v13, v33, v32, s14
v_perm_b32 v14, v37, v36, s14
v_perm_b32 v13, v34, v13, s21
v_perm_b32 v14, v38, v14, s21
v_xor_b32 v13, s20, v13
v_xor_b32 v14, s20, v14
v_or_b32 v15, v13, v14
s_nop 1
v_or_b32_dpp v15, v15, v15 quad_perm:[1,0,3,2] row_mask:0xf bank_mask:0xf
s_nop 1
v_or_b32_dpp v15, v15, v15 quad_perm:[2,3,0,1] row_mask:0xf bank_mask:0xf
v_cmp_ne_u32 vcc, 0, v15
s_cbranch_vccnz L_o_retry_36
L_o_exit_38:
s_mov_b64 exec, s[80:81]
L_o_done_37:
v_and_b32 v40, 0xff, v35
v_and_b32 v41, 0xff, v39
v_lshlrev_b32 v40, v245, v40
v_lshlrev_b32 v41, v245, v41
v_and_b32 v32, s23, v32
v_and_b32 v33, s23, v33
v_and_b32 v34, s23, v34
v_and_b32 v35, s23, v35
v_or_b32_dpp v40, v40, v40 quad_perm:[1,0,3,2] row_mask:0xf bank_mask:0xf
v_or_b32_dpp v41, v41, v41 quad_perm:[1,0,3,2] row_mask:0xf bank_mask:0xf
v_and_b32 v36, s23, v36
v_and_b32 v37, s23, v37
v_and_b32 v38, s23, v38
v_and_b32 v39, s23, v39
v_or_b32_dpp v40, v40, v40 quad_perm:[2,3,0,1] row_mask:0xf bank_mask:0xf
v_or_b32_dpp v41, v41, v41 quad_perm:[2,3,0,1] row_mask:0xf bank_mask:0xf
v_max_f32 v10, v40, v41
s_nop 1
v_max_f32_dpp v10, v10, v10 row_ror:4 row_mask:0xf bank_mask:0xf
s_nop 1
v_max_f32_dpp v10, v10, v10 row_ror:8 row_mask:0xf bank_mask:0xf
v_mov_b32 v11, v10
s_nop 1
v_permlane16_swap_b32 v10, v11
v_max_f32 v10, v10, v11
v_mov_b32 v11, v10
s_nop 1
v_permlane32_swap_b32 v10, v11
v_max_f32 v10, v10, v11
v_sub_f32 v40, v40, v10
v_sub_f32 v41, v41, v10
v_exp_f32 v40, v40
v_exp_f32 v41, v41
s_nop 0
v_pk_mul_f32 v[32:33], v[32:33], v[40:41] op_sel_hi:[1,0]
v_pk_mul_f32 v[34:35], v[34:35], v[40:41] op_sel_hi:[1,0]
v_pk_fma_f32 v[32:33], v[36:37], v[40:41], v[32:33] op_sel:[0,1,0] op_sel_hi:[1,1,1]
v_pk_fma_f32 v[34:35], v[38:39], v[40:41], v[34:35] op_sel:[0,1,0] op_sel_hi:[1,1,1]
v_add_f32 v11, v40, v41
v_mov_b32 v14, v11
v_permlane32_swap_b32 v32, v34
v_permlane32_swap_b32 v33, v35
v_permlane32_swap_b32 v11, v14
v_add_f32 v11, v11, v14
v_add_f32 v32, v32, v34
v_add_f32 v33, v33, v35
v_mov_b32 v14, v11
s_nop 0
v_permlane16_swap_b32 v32, v33
v_permlane16_swap_b32 v11, v14
v_add_f32 v32, v32, v33
v_add_f32 v11, v11, v14
s_nop 0
v_add_f32_dpp v32, v32, v32 row_ror:8 row_mask:0xf bank_mask:0xf
v_add_f32_dpp v11, v11, v11 row_ror:8 row_mask:0xf bank_mask:0xf
s_nop 0
v_add_f32_dpp v32, v32, v32 row_ror:4 row_mask:0xf bank_mask:0xf
v_add_f32_dpp v11, v11, v11 row_ror:4 row_mask:0xf bank_mask:0xf
v_rcp_f32 v10, v11
s_nop 0
v_mul_f32 v32, v32, v10
v_cvt_pk_bf16_f32 v32, v32, v32
s_mov_b32 exec_lo, 0x000f000f
s_mov_b32 exec_hi, 0x000f000f
ds_write_b16 v239, v32 offset:10752
s_mov_b64 exec, -1
s_waitcnt lgkmcnt(0)
L_skip_35:
s_barrier
ds_read_b128 v[60:63], v238 offset:10752
s_waitcnt lgkmcnt(0)
v_mfma_f32_16x16x32_bf16 v[16:19], v[60:63], v[128:131], 0
v_mfma_f32_16x16x32_bf16 v[20:23], v[60:63], v[132:135], 0
v_mfma_f32_16x16x32_bf16 v[24:27], v[60:63], v[136:139], 0
v_mfma_f32_16x16x32_bf16 v[28:31], v[60:63], v[140:143], 0
v_mfma_f32_16x16x32_bf16 v[32:35], v[60:63], v[144:147], 0
v_mfma_f32_16x16x32_bf16 v[36:39], v[60:63], v[148:151], 0
v_mfma_f32_16x16x32_bf16 v[40:43], v[60:63], v[152:155], 0
v_mfma_f32_16x16x32_bf16 v[44:47], v[60:63], v[156:159], 0
s_mov_b64 exec, 0xffff
v_perm_b32 v192, v16, v6, s10
v_perm_b32 v193, v20, v6, s11
v_perm_b32 v194, v24, v6, s12
v_perm_b32 v195, v28, v6, s13
buffer_store_dwordx4 v[192:195], v3, s[56:59], s38 offen offset:0 sc1
v_perm_b32 v196, v32, v6, s10
v_perm_b32 v197, v36, v6, s11
v_perm_b32 v198, v40, v6, s12
v_perm_b32 v199, v44, v6, s13
buffer_store_dwordx4 v[196:199], v3, s[56:59], s38 offen offset:256 sc1
v_perm_b32 v200, v17, v6, s10
v_perm_b32 v201, v21, v6, s11
v_perm_b32 v202, v25, v6, s12
v_perm_b32 v203, v29, v6, s13
buffer_store_dwordx4 v[200:203], v3, s[56:59], s38 offen offset:512 sc1
v_perm_b32 v204, v33, v6, s10
v_perm_b32 v205, v37, v6, s11
v_perm_b32 v206, v41, v6, s12
v_perm_b32 v207, v45, v6, s13
buffer_store_dwordx4 v[204:207], v3, s[56:59], s38 offen offset:768 sc1
s_mov_b64 exec, -1
s_branch L_fini
L_ftype_31:
v_lshrrev_b32 v10, 4, v1
v_lshl_add_u32 v10, v10, 2, v244
s_mov_b32 s24, 0x000f000f
s_mov_b32 s25, 0x000f000f
s_cmp_eq_u32 s85, 0
s_cbranch_scc1 L_skip_39
s_add_u32 s22, s71, 2048
buffer_load_dwordx4 v[176:179], v5, s[52:55], s22 offen nt
s_add_u32 s22, s71, 18432
buffer_load_dwordx4 v[180:183], v5, s[52:55], s22 offen nt
s_add_u32 s22, s71, 34816
buffer_load_dwordx4 v[184:187], v5, s[52:55], s22 offen nt
s_add_u32 s22, s71, 51200
buffer_load_dwordx4 v[188:191], v5, s[52:55], s22 offen nt
ds_read_b128 v[60:63], v238 offset:10752
s_waitcnt vmcnt(0)
v_perm_b32 v96, v164, v160, s8
v_perm_b32 v100, v164, v160, s9
v_perm_b32 v104, v165, v161, s8
v_perm_b32 v108, v165, v161, s9
v_perm_b32 v112, v166, v162, s8
v_perm_b32 v116, v166, v162, s9
v_perm_b32 v120, v167, v163, s8
v_perm_b32 v124, v167, v163, s9
v_perm_b32 v97, v172, v168, s8
v_perm_b32 v101, v172, v168, s9
v_perm_b32 v105, v173, v169, s8
v_perm_b32 v109, v173, v169, s9
v_perm_b32 v113, v174, v170, s8
v_perm_b32 v117, v174, v170, s9
v_perm_b32 v121, v175, v171, s8
v_perm_b32 v125, v175, v171, s9
v_perm_b32 v98, v180, v176, s8
v_perm_b32 v102, v180, v176, s9
v_perm_b32 v106, v181, v177, s8
v_perm_b32 v110, v181, v177, s9
v_perm_b32 v114, v182, v178, s8
v_perm_b32 v118, v182, v178, s9
v_perm_b32 v122, v183, v179, s8
v_perm_b32 v126, v183, v179, s9
v_perm_b32 v99, v188, v184, s8
v_perm_b32 v103, v188, v184, s9
v_perm_b32 v107, v189, v185, s8
v_perm_b32 v111, v189, v185, s9
v_perm_b32 v115, v190, v186, s8
v_perm_b32 v119, v190, v186, s9
v_perm_b32 v123, v191, v187, s8
v_perm_b32 v127, v191, v187, s9
s_waitcnt lgkmcnt(0)
v_mfma_f32_16x16x32_bf16 v[16:19], v[60:63], v[96:99], 0
v_mfma_f32_16x16x32_bf16 v[20:23], v[60:63], v[100:103], 0
v_mfma_f32_16x16x32_bf16 v[24:27], v[60:63], v[104:107], 0
v_mfma_f32_16x16x32_bf16 v[28:31], v[60:63], v[108:111], 0
v_mfma_f32_16x16x32_bf16 v[32:35], v[60:63], v[112:115], 0
v_mfma_f32_16x16x32_bf16 v[36:39], v[60:63], v[116:119], 0
v_mfma_f32_16x16x32_bf16 v[40:43], v[60:63], v[120:123], 0
v_mfma_f32_16x16x32_bf16 v[44:47], v[60:63], v[124:127], 0
s_mov_b64 exec, 0xffff
v_perm_b32 v64, v16, v6, s10
v_perm_b32 v65, v20, v6, s11
v_perm_b32 v66, v24, v6, s12
v_perm_b32 v67, v28, v6, s13
buffer_store_dwordx4 v[64:67], v3, s[56:59], s38 offen offset:0 sc1
v_perm_b32 v68, v32, v6, s10
v_perm_b32 v69, v36, v6, s11
v_perm_b32 v70, v40, v6, s12
v_perm_b32 v71, v44, v6, s13
buffer_store_dwordx4 v[68:71], v3, s[56:59], s38 offen offset:256 sc1
v_perm_b32 v72, v17, v6, s10
v_perm_b32 v73, v21, v6, s11
v_perm_b32 v74, v25, v6, s12
v_perm_b32 v75, v29, v6, s13
buffer_store_dwordx4 v[72:75], v3, s[56:59], s38 offen offset:512 sc1
v_perm_b32 v76, v33, v6, s10
v_perm_b32 v77, v37, v6, s11
v_perm_b32 v78, v41, v6, s12
v_perm_b32 v79, v45, v6, s13
buffer_store_dwordx4 v[76:79], v3, s[56:59], s38 offen offset:768 sc1
s_mov_b64 exec, -1
L_skip_39:
s_cmp_eq_u32 s3, 7
s_cselect_b32 s17, s16, s17
s_cselect_b32 s19, 0, -1
s_cmp_lg_u32 s3, 0
s_cbranch_scc1 L_skip_40
v_lshlrev_b32 v138, 2, v1
v_and_b32 v139, 12, v1
v_lshlrev_b32 v139, 2, v139
v_and_b32 v11, 3, v1
v_lshl_add_u32 v139, v11, 1, v139
buffer_load_ushort v137, v139, s[60:63], s18 offen
s_mov_b32 exec_lo, 0x11111111
s_mov_b32 exec_hi, 0x11111111
s_mov_b32 s15, 0
L_sp_41:
buffer_load_dwordx4 v[128:131], v242, s[56:59], s16 offen sc1
s_add_u32 s15, s15, 1
s_cmp_gt_u32 s15, 131072
s_waitcnt vmcnt(0)
s_cbranch_scc1 L_spx_42
v_perm_b32 v13, v129, v128, s14
v_perm_b32 v14, v131, v130, s14
v_perm_b32 v13, v14, v13, s8
v_xor_b32 v15, v13, v6
v_cmp_eq_u32 vcc, 0, v15
s_bcnt1_i32_b64 s7, vcc
s_cmp_ge_u32 s7, 6
s_cbranch_scc1 L_spx_42
s_sleep 2
s_branch L_sp_41
L_spx_42:
s_mov_b64 exec, -1
v_lshlrev_b32 v137, 16, v137
L_skip_40:
s_and_b32 s19, s19, s23
s_barrier
buffer_load_dwordx4 v[128:131], v242, s[56:59], s16 offen sc1
buffer_load_dwordx4 v[192:195], v242, s[56:59], s17 offen sc1
s_waitcnt vmcnt(0)
v_perm_b32 v13, v129, v128, s14
v_perm_b32 v14, v131, v130, s14
v_perm_b32 v13, v14, v13, s8
v_xor_b32 v15, v13, v6
v_perm_b32 v13, v193, v192, s14
v_perm_b32 v14, v195, v194, s14
v_perm_b32 v13, v14, v13, s8
v_xor_b32 v13, v13, v6
v_or_b32 v15, v15, v13
s_nop 1
v_or_b32_dpp v15, v15, v15 quad_perm:[1,0,3,2] row_mask:0xf bank_mask:0xf
s_nop 1
v_or_b32_dpp v15, v15, v15 quad_perm:[2,3,0,1] row_mask:0xf bank_mask:0xf
v_cmp_ne_u32 vcc, 0, v15
s_cbranch_vccz L_ga_done_44
s_mov_b32 s15, 0
s_mov_b64 s[80:81], exec
L_ga_retry_43:
s_mov_b64 exec, vcc
s_nop 4
buffer_load_dwordx4 v[128:131], v242, s[56:59], s16 offen sc1
buffer_load_dwordx4 v[192:195], v242, s[56:59], s17 offen sc1
s_add_u32 s15, s15, 1
s_cmp_gt_u32 s15, 131072
s_waitcnt vmcnt(0)
s_cbranch_scc1 L_ga_exit_45
v_perm_b32 v13, v129, v128, s14
v_perm_b32 v14, v131, v130, s14
v_perm_b32 v13, v14, v13, s8
v_xor_b32 v15, v13, v6
v_perm_b32 v13, v193, v192, s14
v_perm_b32 v14, v195, v194, s14
v_perm_b32 v13, v14, v13, s8
v_xor_b32 v13, v13, v6
v_or_b32 v15, v15, v13
s_nop 1
v_or_b32_dpp v15, v15, v15 quad_perm:[1,0,3,2] row_mask:0xf bank_mask:0xf
s_nop 1
v_or_b32_dpp v15, v15, v15 quad_perm:[2,3,0,1] row_mask:0xf bank_mask:0xf
v_cmp_ne_u32 vcc, 0, v15
s_cbranch_vccnz L_ga_retry_43
L_ga_exit_45:
s_mov_b64 exec, s[80:81]
L_ga_done_44:
v_and_b32 v128, s23, v128
v_and_b32 v129, s23, v129
v_and_b32 v130, s23, v130
v_and_b32 v131, s23, v131
v_and_b32 v192, s19, v192
v_and_b32 v193, s19, v193
v_and_b32 v194, s19, v194
v_and_b32 v195, s19, v195
v_permlane32_swap_b32 v128, v130
v_permlane32_swap_b32 v129, v131
v_add_f32 v128, v128, v130
v_add_f32 v129, v129, v131
s_nop 1
v_permlane16_swap_b32 v128, v129
v_add_f32 v128, v128, v129
s_nop 1
v_add_f32_dpp v128, v128, v128 row_ror:8 row_mask:0xf bank_mask:0xf
s_nop 1
v_add_f32_dpp v128, v128, v128 row_ror:4 row_mask:0xf bank_mask:0xf
v_permlane32_swap_b32 v192, v194
v_permlane32_swap_b32 v193, v195
v_add_f32 v192, v192, v194
v_add_f32 v193, v193, v195
s_nop 1
v_permlane16_swap_b32 v192, v193
v_add_f32 v192, v192, v193
s_nop 1
v_add_f32_dpp v192, v192, v192 row_ror:8 row_mask:0xf bank_mask:0xf
s_nop 1
v_add_f32_dpp v192, v192, v192 row_ror:4 row_mask:0xf bank_mask:0xf
s_mov_b64 exec, s[24:25]
ds_write_b32 v10, v128 offset:0
ds_write_b32 v10, v192 offset:512
s_waitcnt lgkmcnt(0)
s_barrier
s_cmp_lg_u32 s3, 0
s_cbranch_scc1 L_fini
s_mov_b64 exec, -1
ds_read2_b32 v[128:129], v138 offset0:0 offset1:64
ds_read2_b32 v[130:131], v138 offset0:128 offset1:192
s_waitcnt lgkmcnt(0)
v_add_f32 v128, v128, v129
v_add_f32 v136, v130, v131
v_mov_b32 v129, v128
v_mov_b32 v130, v136
s_nop 0
v_permlane16_swap_b32 v128, v129
v_permlane16_swap_b32 v136, v130
v_add_f32 v128, v128, v129
v_add_f32 v136, v136, v130
v_mov_b32 v129, v128
v_mov_b32 v130, v136
s_nop 0
v_permlane32_swap_b32 v128, v129
v_permlane32_swap_b32 v136, v130
v_add_f32 v128, v128, v129
v_add_f32 v136, v136, v130
v_cvt_pk_bf16_f32 v129, v128, v136
v_lshlrev_b32 v128, 16, v129
v_and_b32 v136, s84, v129
v_add_f32 v128, v137, v128
v_cvt_pk_bf16_f32 v128, v128, v128
v_and_b32 v128, s84, v128
v_add_f32 v128, v128, v136
v_cvt_pk_bf16_f32 v128, v128, v128
s_mov_b64 exec, 0xffff
buffer_store_short v128, v139, s[64:67], s18 offen
s_cmp_lg_u32 s5, 0
s_cbranch_scc1 L_fini
s_mov_b64 exec, 1
buffer_store_dword v6, off, s[56:59], 0
L_fini:
L_end:
s_endpgm
.section .rodata,"a"
.p2align 6
.amdhsa_kernel parallel_sum__gqa_block_cached__dense_activation_silu__decode_kernel
  .amdhsa_next_free_vgpr 256
  .amdhsa_next_free_sgpr 102
  .amdhsa_accum_offset 256
  .amdhsa_group_segment_fixed_size 0
  .amdhsa_kernarg_size 88
  .amdhsa_user_sgpr_count 2
  .amdhsa_user_sgpr_kernarg_segment_ptr 1
  .amdhsa_system_sgpr_workgroup_id_x 1
.end_amdhsa_kernel
```
